```python
import torch

def _softmax(x, axis=-1):
    return torch.softmax(x, dim=axis)
def _gelu(x):
    return torch.nn.functional.gelu(x, approximate="tanh")
def _silu(x):
    return torch.nn.functional.silu(x)
def _sigmoid(x):
    return torch.sigmoid(x)
def _layernorm(x, axis=-1, eps=1e-5):
    m = x.mean(dim=axis, keepdim=True)
    v = x.var(dim=axis, keepdim=True, unbiased=False)
    return (x - m) / torch.sqrt(v + eps)
def _scatter_add(tgt, idx, src, axis=0):
    return tgt.clone().index_add_(axis, idx, src)
def _segment_sum(src, seg, n):
    out = torch.zeros((n,) + src.shape[1:], dtype=src.dtype)
    return out.index_add_(0, seg, src)
def _pad(x, pw):
    flat = tuple(v for pair in reversed(pw) for v in pair)
    return torch.nn.functional.pad(x, flat)

kernel_name = 'standalone__qk_norm__prompt'

def setup_inputs():

    _w = (lambda a: (lambda t: t.to(torch.bfloat16) if t.is_floating_point() else t)(torch.as_tensor(a)))
    B, H, S, D = 1, 16, 4096, 448
    Dh = D // H
    return {
        "q": _w((lambda *s: torch.randn(*s, dtype=torch.bfloat16) * 0.05)(B, H, S, Dh)),
        "k": _w((lambda *s: torch.randn(*s, dtype=torch.bfloat16) * 0.05)(B, H, S, Dh)),
        "v": _w((lambda *s: torch.randn(*s, dtype=torch.bfloat16) * 0.8)(B, H, S, Dh)),
        "t": _w(torch.abs((lambda *s: torch.randn(*s, dtype=torch.bfloat16) * 0.8)(H)) + 1.0),
    }

def reference(q, k, v, t):
    eps = 1e-6
    qn = q / (torch.sqrt((q * q).sum(axis=-1, keepdims=True)) + eps)
    kn = k / (torch.sqrt((k * k).sum(axis=-1, keepdims=True)) + eps)
    logits = torch.einsum('bhqd,bhkd->bhqk', qn, kn) * t[None, :, None, None]
    attn = _softmax(logits, axis=-1)
    return torch.einsum('bhqk,bhkd->bhqd', attn, v)
```

```asm
; @launch grid=(256,1,1) block=(512,1,1) lds=163840
.amdgcn_target "amdgcn-amd-amdhsa--gfx950"
.text
.globl standalone__qk_norm__prompt_kernel
.p2align 8
.type standalone__qk_norm__prompt_kernel,@function
standalone__qk_norm__prompt_kernel:
    s_cmp_ge_u32 s2, 256
    s_cbranch_scc1 L_end
    s_load_dwordx8 s[4:11], s[0:1], 0
    s_load_dwordx4 s[12:15], s[0:1], 32
    s_load_dwordx2 s[16:17], s[0:1], 48
    s_getpc_b64 s[70:71]
L_pc:
    v_lshlrev_b32 v16, 7, v0
    v_mov_b32 v17, s71
    v_add_co_u32 v16, vcc, s70, v16
    s_nop 1
    v_addc_co_u32 v17, vcc, 0, v17, vcc
    v_cmp_ge_u32 vcc, (L_end - L_pc) >> 7, v0
    s_and_saveexec_b64 s[70:71], vcc
    s_cbranch_execz L_nopf
    global_load_dword v253, v[16:17], off
L_nopf:
    s_mov_b64 exec, -1
    v_lshrrev_b32 v1, 6, v0
    v_and_b32 v0, 63, v0
    v_readfirstlane_b32 s46, v1
    s_and_b32 s44, s2, 7
    s_lshl_b32 s44, s44, 1
    s_lshr_b32 s64, s2, 7
    s_add_u32 s44, s44, s64
    s_bfe_u32 s45, s2, 0x40003
    v_mul_u32_u24 v2, 28, v0
    v_lshlrev_b32 v3, 4, v0
    s_mul_i32 s64, s44, 229376
    s_mul_i32 s56, s46, 1792
    s_mul_i32 s60, s45, 14336
    s_add_u32 s60, s60, s56
    s_cmp_eq_u32 s45, 0
    s_cselect_b32 s51, 14336, 0
    s_add_u32 s51, s51, s56
    s_and_b32 s67, s44, 14
    s_lshl_b32 s67, s67, 1
    s_mov_b32 s26, 229376
    s_mov_b32 s27, 0x00020000
    s_mov_b32 s22, 229376
    s_mov_b32 s23, 0x00020000
    s_mov_b32 s30, 229376
    s_mov_b32 s31, 0x00020000
    s_lshl_b32 s52, s46, 12
    s_lshl_b32 s55, s46, 11
    s_and_b32 s47, s46, 3
    s_lshr_b32 s48, s46, 2
    v_mov_b32 v192, 0
    v_mov_b32 v193, 0
    v_mov_b32 v194, 0
    v_mov_b32 v195, 0
    v_mov_b32 v176, 0x3f80
    v_mov_b32 v177, 0
    v_mov_b32 v178, 0x3f80
    v_mov_b32 v179, 0
    v_mfma_f32_32x32x16_bf16 v[48:63], v[192:195], v[192:195], 0
    s_add_u32 m0, s52, 67584
    s_waitcnt lgkmcnt(0)
    s_add_u32 s24, s6, s64
    s_addc_u32 s25, s7, 0
    buffer_load_dwordx4 v[112:115], v2, s[24:27], s51 offen
    buffer_load_dwordx3 v[116:118], v2, s[24:27], s51 offen offset:16
    s_load_dword s57, s[10:11], s67
    v_lshlrev_b32 v1, 11, v0
    v_and_b32 v1, 0x18000, v1
    v_and_b32 v6, 0xf0, v3
    v_add3_u32 v1, v1, v6, s52
    ds_write_b128 v1, v[176:179] offset:3840
    v_mfma_f32_32x32x16_bf16 v[64:79], v[192:195], v[192:195], 0
    s_add_u32 s69, s55, 131072
    v_and_b32 v1, 1, v0
    v_lshlrev_b32 v1, 9, v1
    v_lshrrev_b32 v241, 1, v0
    v_lshl_add_u32 v15, v241, 4, v1
    v_add_u32 v241, s52, v15
    v_add_u32 v240, 65536, v241
    v_add_u32 v14, s69, v15
    v_mfma_f32_32x32x16_bf16 v[80:95], v[192:195], v[192:195], 0
    s_mov_b32 s62, -1
    s_add_u32 s20, s4, s64
    s_addc_u32 s21, s5, 0
    buffer_load_dwordx4 v[120:123], v2, s[20:23], s60 offen
    buffer_load_dwordx3 v[124:126], v2, s[20:23], s60 offen offset:16
    s_add_u32 s28, s8, s64
    s_addc_u32 s29, s9, 0
    v_lshrrev_b32 v1, 5, v0
    v_mul_u32_u24 v243, 448, v1
    v_bfe_u32 v1, v0, 2, 2
    v_mad_u32_u24 v243, v1, 56, v243
    v_and_b32 v1, 1, v0
    v_lshl_add_u32 v243, v1, 5, v243
    v_bfe_u32 v1, v0, 4, 1
    v_lshl_add_u32 v243, v1, 4, v243
    v_bfe_u32 v1, v0, 1, 1
    v_lshl_add_u32 v243, v1, 3, v243
    v_and_b32 v1, 19, v0
    v_cmp_eq_u32 vcc, 19, v1
    v_add_u32 v244, 2944, v243
    v_add_u32 v243, 2048, v243
    v_mov_b32 v6, 3840
    v_cndmask_b32 v243, v243, v6, vcc
    v_cndmask_b32 v244, v244, v6, vcc
    v_mfma_f32_32x32x16_bf16 v[96:111], v[192:195], v[192:195], 0
    s_mov_b32 s63, 0xffff
    s_lshl_b32 s68, s47, 12
    s_add_u32 s69, s68, 65536
    v_add_u32 v4, s69, v3
    v_add_u32 v8, s69, v243
    v_add_u32 v9, s69, v244
    v_add_u32 v250, s68, v3
    v_add_u32 v251, s68, v243
    v_add_u32 v252, s68, v244
    v_mov_b32 v242, v3
    v_mov_b32 v7, 0xdddddddd
    v_mov_b32 v119, 0x3f80
    v_and_b32 v1, 31, v0
    v_mul_u32_u24 v1, 56, v1
    v_lshrrev_b32 v6, 5, v0
    v_lshl_add_u32 v5, v6, 5, v1
    v_mov_b32 v215, 0x3f80
    v_mov_b32 v223, 0x3f80
    v_mov_b32 v231, 0x3f80
    s_lshl_b32 s69, s48, 13
    s_add_u32 s69, s69, 131072
    s_lshl_b32 s68, s47, 11
    v_add_u32 v1, s68, v3
    v_add_u32 v6, 2048, v1
    v_and_b32 v6, 0x1fff, v6
    v_add_u32 v10, s69, v6
    v_add_u32 v6, 4096, v1
    v_and_b32 v6, 0x1fff, v6
    v_add_u32 v11, s69, v6
    v_add_u32 v6, 6144, v1
    v_and_b32 v6, 0x1fff, v6
    v_add_u32 v12, s69, v6
    v_add_u32 v6, 8192, v1
    v_and_b32 v6, 0x1fff, v6
    v_add_u32 v13, s69, v6
    s_cmp_le_u32 s45, 1
    s_cselect_b32 s53, 2, 1
    s_mul_i32 s53, s53, 14336
    s_add_u32 s53, s53, s56
    s_cmp_le_u32 s45, 2
    s_cselect_b32 s61, 3, 2
    s_mul_i32 s61, s61, 14336
    s_add_u32 s61, s61, s56
    s_lshl_b32 s65, s44, 18
    s_lshl_b32 s66, s44, 4
    s_mov_b32 s38, 262144
    s_mov_b32 s42, 16
    s_mov_b32 s34, 229376
    s_mov_b32 s39, 0x00020000
    s_mov_b32 s43, 0x00020000
    s_mov_b32 s35, 0x00020000
    s_cmp_lt_u32 s46, 4
    s_cselect_b64 vcc, -1, 0
    s_cbranch_vccnz L_prio_1
    s_setprio 1
L_prio_1:
    buffer_load_dwordx4 v3, s[28:31], s51 offen offset:0 lds
    s_mov_b64 exec, s[62:63]
    buffer_load_dwordx4 v3, s[28:31], s51 offen offset:1024 lds
    s_mov_b64 exec, -1
    s_waitcnt vmcnt(4)
    v_dot2_f32_bf16 v136, v112, v112, 0
    v_dot2_f32_bf16 v137, v113, v113, 0
    v_dot2_f32_bf16 v136, v114, v114, v136
    v_dot2_f32_bf16 v137, v115, v115, v137
    v_dot2_f32_bf16 v136, v116, v116, v136
    v_dot2_f32_bf16 v137, v117, v117, v137
    v_dot2_f32_bf16 v136, v118, v118, v136
    s_nop 2
    v_add_f32 v136, v136, v137
    v_lshlrev_b32 v128, 16, v112
    v_and_b32 v129, 0xffff0000, v112
    v_add_f32_dpp v136, v136, v136 quad_perm:[1,0,3,2] row_mask:0xf bank_mask:0xf
    v_sqrt_f32 v136, v136
    v_lshlrev_b32 v130, 16, v113
    v_add_f32 v136, 0x358637bd, v136
    v_rcp_f32 v136, v136
    v_and_b32 v131, 0xffff0000, v113
    v_lshlrev_b32 v132, 16, v114
    v_and_b32 v133, 0xffff0000, v114
    v_pk_mul_f32 v[128:129], v[128:129], v[136:137] op_sel_hi:[1,0]
    v_cvt_pk_bf16_f32 v112, v128, v129
    v_lshlrev_b32 v128, 16, v115
    v_and_b32 v129, 0xffff0000, v115
    v_pk_mul_f32 v[130:131], v[130:131], v[136:137] op_sel_hi:[1,0]
    v_cvt_pk_bf16_f32 v113, v130, v131
    v_lshlrev_b32 v130, 16, v116
    v_and_b32 v131, 0xffff0000, v116
    v_pk_mul_f32 v[132:133], v[132:133], v[136:137] op_sel_hi:[1,0]
    v_cvt_pk_bf16_f32 v114, v132, v133
    v_lshlrev_b32 v132, 16, v117
    v_and_b32 v133, 0xffff0000, v117
    v_pk_mul_f32 v[128:129], v[128:129], v[136:137] op_sel_hi:[1,0]
    v_cvt_pk_bf16_f32 v115, v128, v129
    ds_write_b128 v240, v[112:115] offset:0
    v_lshlrev_b32 v128, 16, v118
    v_and_b32 v129, 0xffff0000, v118
    v_pk_mul_f32 v[130:131], v[130:131], v[136:137] op_sel_hi:[1,0]
    v_cvt_pk_bf16_f32 v116, v130, v131
    v_pk_mul_f32 v[132:133], v[132:133], v[136:137] op_sel_hi:[1,0]
    v_cvt_pk_bf16_f32 v117, v132, v133
    v_pk_mul_f32 v[128:129], v[128:129], v[136:137] op_sel_hi:[1,0]
    v_cvt_pk_bf16_f32 v118, v128, v129
    ds_write_b128 v240, v[116:119] offset:1024
    buffer_load_dwordx4 v[208:211], v2, s[24:27], s60 offen
    buffer_load_dwordx3 v[212:214], v2, s[24:27], s60 offen offset:16
    s_waitcnt lgkmcnt(0)
    s_bitcmp1_b32 s44, 0
    s_cselect_b32 s67, 16, 0
    s_lshr_b32 s57, s57, s67
    s_and_b32 s67, s57, 0x7fff
    s_lshl_b32 s57, s57, 16
    v_mov_b32 v1, 0x3fb8aa3b
    v_mul_f32 v1, s57, v1
    s_cmp_gt_u32 s67, 0x41a6
    v_readfirstlane_b32 s58, v1
    v_mul_f32 v6, -0.5, abs(v1)
    v_cvt_pk_bf16_f32 v127, v6, 0
    s_cbranch_scc1 L_slow0
    s_waitcnt vmcnt(4)
    v_dot2_f32_bf16 v136, v120, v120, 0
    v_dot2_f32_bf16 v137, v121, v121, 0
    v_dot2_f32_bf16 v136, v122, v122, v136
    v_dot2_f32_bf16 v137, v123, v123, v137
    v_dot2_f32_bf16 v136, v124, v124, v136
    v_dot2_f32_bf16 v137, v125, v125, v137
    v_dot2_f32_bf16 v136, v126, v126, v136
    s_nop 2
    v_add_f32 v136, v136, v137
    v_lshlrev_b32 v128, 16, v120
    v_and_b32 v129, 0xffff0000, v120
    v_add_f32_dpp v136, v136, v136 quad_perm:[1,0,3,2] row_mask:0xf bank_mask:0xf
    v_sqrt_f32 v136, v136
    v_lshlrev_b32 v130, 16, v121
    v_add_f32 v136, 0x358637bd, v136
    v_rcp_f32 v136, v136
    v_and_b32 v131, 0xffff0000, v121
    v_mul_f32 v136, s58, v136
    v_lshlrev_b32 v132, 16, v122
    v_and_b32 v133, 0xffff0000, v122
    v_pk_mul_f32 v[128:129], v[128:129], v[136:137] op_sel_hi:[1,0]
    v_cvt_pk_bf16_f32 v120, v128, v129
    v_lshlrev_b32 v128, 16, v123
    v_and_b32 v129, 0xffff0000, v123
    v_pk_mul_f32 v[130:131], v[130:131], v[136:137] op_sel_hi:[1,0]
    v_cvt_pk_bf16_f32 v121, v130, v131
    v_lshlrev_b32 v130, 16, v124
    v_and_b32 v131, 0xffff0000, v124
    v_pk_mul_f32 v[132:133], v[132:133], v[136:137] op_sel_hi:[1,0]
    v_cvt_pk_bf16_f32 v122, v132, v133
    v_lshlrev_b32 v132, 16, v125
    v_and_b32 v133, 0xffff0000, v125
    v_pk_mul_f32 v[128:129], v[128:129], v[136:137] op_sel_hi:[1,0]
    v_cvt_pk_bf16_f32 v123, v128, v129
    ds_write_b128 v14, v[120:123] offset:0
    v_lshlrev_b32 v128, 16, v126
    v_and_b32 v129, 0xffff0000, v126
    v_pk_mul_f32 v[130:131], v[130:131], v[136:137] op_sel_hi:[1,0]
    v_cvt_pk_bf16_f32 v124, v130, v131
    v_pk_mul_f32 v[132:133], v[132:133], v[136:137] op_sel_hi:[1,0]
    v_cvt_pk_bf16_f32 v125, v132, v133
    v_pk_mul_f32 v[128:129], v[128:129], v[136:137] op_sel_hi:[1,0]
    v_cvt_pk_bf16_f32 v126, v128, v129
    ds_write_b128 v14, v[124:127] offset:1024
    s_waitcnt vmcnt(2) lgkmcnt(0)
    s_barrier
    ds_read_b128 v[176:179], v4 offset:0
    ds_read_b128 v[180:183], v4 offset:1024
    ds_read_b128 v[16:19], v10
    ds_read_b128 v[20:23], v10 offset:1024
    ds_read_b128 v[24:27], v11
    ds_read_b128 v[28:31], v11 offset:1024
    ds_read_b128 v[32:35], v12
    ds_read_b128 v[36:39], v12 offset:1024
    ds_read_b128 v[40:43], v13
    ds_read_b128 v[44:47], v13 offset:1024
    ds_read_b64_tr_b16 v[192:193], v8 offset:0
    ds_read_b64_tr_b16 v[194:195], v8 offset:224
    ds_read_b64_tr_b16 v[196:197], v9 offset:0
    ds_read_b64_tr_b16 v[198:199], v9 offset:224
    s_setprio 1
    s_add_u32 s36, s16, s65
    s_addc_u32 s37, s17, 0
    s_lshl_b32 s50, s45, 14
    s_add_u32 s50, s50, s55
    s_waitcnt lgkmcnt(10)
    v_mfma_f32_32x32x16_bf16 v[112:127], v[176:179], v[16:19], 0
    v_mfma_f32_32x32x16_bf16 v[112:127], v[180:183], v[20:23], v[112:127]
    s_add_u32 s40, s14, s66
    s_addc_u32 s41, s15, 0
    s_add_u32 s32, s12, s64
    s_addc_u32 s33, s13, 0
    s_max_u32 s18, s45, 3
    s_mov_b32 s49, 3
    s_mov_b32 s59, 0
    s_mov_b32 s54, 3
    s_waitcnt lgkmcnt(4)
    s_nop 1
    v_mfma_f32_32x32x16_bf16 v[128:143], v[176:179], v[24:27], 0
    v_exp_f32 v112, v112
    v_exp_f32 v113, v113
    v_exp_f32 v114, v114
    v_exp_f32 v115, v115
    s_waitcnt vmcnt(0)
    v_dot2_f32_bf16 v246, v208, v208, 0
    v_dot2_f32_bf16 v247, v209, v209, 0
    v_dot2_f32_bf16 v246, v210, v210, v246
    v_dot2_f32_bf16 v247, v211, v211, v247
    v_dot2_f32_bf16 v246, v212, v212, v246
    v_dot2_f32_bf16 v247, v213, v213, v247
    v_dot2_f32_bf16 v246, v214, v214, v246
    v_mfma_f32_32x32x16_bf16 v[128:143], v[180:183], v[28:31], v[128:143]
    buffer_load_dwordx4 v[216:219], v2, s[24:27], s53 offen
    v_exp_f32 v116, v116
    v_exp_f32 v117, v117
    v_exp_f32 v118, v118
    v_exp_f32 v119, v119
    v_add_f32 v246, v246, v247
    v_lshlrev_b32 v232, 16, v208
    v_and_b32 v233, 0xffff0000, v208
    v_add_f32_dpp v246, v246, v246 quad_perm:[1,0,3,2] row_mask:0xf bank_mask:0xf
    v_sqrt_f32 v246, v246
    v_lshlrev_b32 v234, 16, v209
    v_add_f32 v246, 0x358637bd, v246
    v_rcp_f32 v246, v246
    v_and_b32 v235, 0xffff0000, v209
    ds_read_b128 v[184:187], v4 offset:16384
    buffer_load_dwordx3 v[220:222], v2, s[24:27], s53 offen offset:16
    v_exp_f32 v120, v120
    v_exp_f32 v121, v121
    v_exp_f32 v122, v122
    v_exp_f32 v123, v123
    v_exp_f32 v124, v124
    v_exp_f32 v125, v125
    v_exp_f32 v126, v126
    v_exp_f32 v127, v127
    v_lshlrev_b32 v236, 16, v210
    v_and_b32 v237, 0xffff0000, v210
    v_pk_mul_f32 v[232:233], v[232:233], v[246:247] op_sel_hi:[1,0]
    v_cvt_pk_bf16_f32 v208, v232, v233
    v_lshlrev_b32 v232, 16, v211
    v_and_b32 v233, 0xffff0000, v211
    v_pk_mul_f32 v[234:235], v[234:235], v[246:247] op_sel_hi:[1,0]
    v_cvt_pk_bf16_f32 v209, v234, v235
    v_mfma_f32_32x32x16_bf16 v[144:159], v[176:179], v[32:35], 0
    s_add_u32 m0, s52, 100352
    s_nop 0
    buffer_load_dwordx4 v3, s[28:31], s53 offen offset:0 lds
    v_exp_f32 v128, v128
    v_exp_f32 v129, v129
    v_exp_f32 v130, v130
    v_exp_f32 v131, v131
    v_lshlrev_b32 v234, 16, v212
    v_and_b32 v235, 0xffff0000, v212
    v_pk_mul_f32 v[236:237], v[236:237], v[246:247] op_sel_hi:[1,0]
    v_cvt_pk_bf16_f32 v210, v236, v237
    v_lshlrev_b32 v236, 16, v213
    v_and_b32 v237, 0xffff0000, v213
    v_pk_mul_f32 v[232:233], v[232:233], v[246:247] op_sel_hi:[1,0]
    v_cvt_pk_bf16_f32 v211, v232, v233
    v_mfma_f32_32x32x16_bf16 v[144:159], v[180:183], v[36:39], v[144:159]
    s_waitcnt lgkmcnt(1)
    buffer_store_dwordx4 v[208:211], v15, s[36:39], s50 offen sc1
    v_exp_f32 v132, v132
    v_exp_f32 v133, v133
    v_exp_f32 v134, v134
    v_exp_f32 v135, v135
    v_smfmac_f32_32x32x32_bf16 v[48:63], v[192:195], v[112:119], v7
    ds_read_b128 v[188:191], v4 offset:17408
    s_mov_b64 exec, s[62:63]
    buffer_load_dwordx4 v3, s[28:31], s53 offen offset:1024 lds
    s_mov_b64 exec, -1
    v_exp_f32 v136, v136
    v_exp_f32 v137, v137
    v_exp_f32 v138, v138
    v_exp_f32 v139, v139
    v_lshlrev_b32 v232, 16, v214
    v_and_b32 v233, 0xffff0000, v214
    v_pk_mul_f32 v[234:235], v[234:235], v[246:247] op_sel_hi:[1,0]
    v_cvt_pk_bf16_f32 v212, v234, v235
    v_pk_mul_f32 v[236:237], v[236:237], v[246:247] op_sel_hi:[1,0]
    v_cvt_pk_bf16_f32 v213, v236, v237
    v_pk_mul_f32 v[232:233], v[232:233], v[246:247] op_sel_hi:[1,0]
    v_cvt_pk_bf16_f32 v214, v232, v233
    v_smfmac_f32_32x32x32_bf16 v[48:63], v[196:199], v[120:127], v7
    ds_write_b128 v241, v[208:211] offset:32768
    ds_write_b128 v241, v[212:215] offset:33792
    buffer_store_dwordx4 v[212:215], v15, s[36:39], s50 offen offset:1024 sc1
    v_exp_f32 v140, v140
    v_exp_f32 v141, v141
    v_exp_f32 v142, v142
    v_exp_f32 v143, v143
    v_mfma_f32_32x32x16_bf16 v[160:175], v[176:179], v[40:43], 0
    v_exp_f32 v144, v144
    v_exp_f32 v145, v145
    v_exp_f32 v146, v146
    v_exp_f32 v147, v147
    s_waitcnt vmcnt(4)
    v_dot2_f32_bf16 v246, v216, v216, 0
    v_dot2_f32_bf16 v247, v217, v217, 0
    v_dot2_f32_bf16 v246, v218, v218, v246
    v_dot2_f32_bf16 v247, v219, v219, v247
    v_dot2_f32_bf16 v246, v220, v220, v246
    v_dot2_f32_bf16 v247, v221, v221, v247
    v_dot2_f32_bf16 v246, v222, v222, v246
    v_mfma_f32_32x32x16_bf16 v[160:175], v[180:183], v[44:47], v[160:175]
    s_cbranch_vccz L_prio_2
    s_setprio 0
L_prio_2:
    v_exp_f32 v148, v148
    v_exp_f32 v149, v149
    v_exp_f32 v150, v150
    v_exp_f32 v151, v151
    v_add_f32 v246, v246, v247
    v_lshlrev_b32 v232, 16, v216
    v_and_b32 v233, 0xffff0000, v216
    v_add_f32_dpp v246, v246, v246 quad_perm:[1,0,3,2] row_mask:0xf bank_mask:0xf
    v_sqrt_f32 v246, v246
    v_lshlrev_b32 v234, 16, v217
    v_add_f32 v246, 0x358637bd, v246
    v_rcp_f32 v246, v246
    v_and_b32 v235, 0xffff0000, v217
    v_smfmac_f32_32x32x32_bf16 v[64:79], v[192:195], v[128:135], v7
    s_waitcnt lgkmcnt(2)
    ds_read_b64_tr_b16 v[200:201], v8 offset:16384
    v_exp_f32 v152, v152
    v_exp_f32 v153, v153
    v_exp_f32 v154, v154
    v_exp_f32 v155, v155
    v_smfmac_f32_32x32x32_bf16 v[64:79], v[196:199], v[136:143], v7
    ds_read_b64_tr_b16 v[202:203], v8 offset:16608
    v_exp_f32 v156, v156
    v_exp_f32 v157, v157
    v_exp_f32 v158, v158
    v_exp_f32 v159, v159
    v_lshlrev_b32 v236, 16, v218
    v_and_b32 v237, 0xffff0000, v218
    v_pk_mul_f32 v[232:233], v[232:233], v[246:247] op_sel_hi:[1,0]
    v_cvt_pk_bf16_f32 v216, v232, v233
    v_lshlrev_b32 v232, 16, v219
    v_and_b32 v233, 0xffff0000, v219
    v_pk_mul_f32 v[234:235], v[234:235], v[246:247] op_sel_hi:[1,0]
    v_cvt_pk_bf16_f32 v217, v234, v235
    v_mfma_f32_32x32x16_bf16 v[112:127], v[184:187], v[16:19], 0
    v_exp_f32 v160, v160
    v_exp_f32 v161, v161
    v_exp_f32 v162, v162
    v_exp_f32 v163, v163
    v_lshlrev_b32 v234, 16, v220
    v_and_b32 v235, 0xffff0000, v220
    v_pk_mul_f32 v[236:237], v[236:237], v[246:247] op_sel_hi:[1,0]
    v_cvt_pk_bf16_f32 v218, v236, v237
    v_lshlrev_b32 v236, 16, v221
    v_and_b32 v237, 0xffff0000, v221
    v_pk_mul_f32 v[232:233], v[232:233], v[246:247] op_sel_hi:[1,0]
    v_cvt_pk_bf16_f32 v219, v232, v233
    v_mfma_f32_32x32x16_bf16 v[112:127], v[188:191], v[20:23], v[112:127]
    buffer_load_dwordx4 v[224:227], v2, s[24:27], s61 offen
    v_exp_f32 v164, v164
    v_exp_f32 v165, v165
    v_exp_f32 v166, v166
    v_exp_f32 v167, v167
    v_smfmac_f32_32x32x32_bf16 v[80:95], v[192:195], v[144:151], v7
    ds_read_b64_tr_b16 v[204:205], v9 offset:16384
    buffer_load_dwordx3 v[228:230], v2, s[24:27], s61 offen offset:16
    v_exp_f32 v168, v168
    v_exp_f32 v169, v169
    v_exp_f32 v170, v170
    v_exp_f32 v171, v171
    v_lshlrev_b32 v232, 16, v222
    v_and_b32 v233, 0xffff0000, v222
    v_pk_mul_f32 v[234:235], v[234:235], v[246:247] op_sel_hi:[1,0]
    v_cvt_pk_bf16_f32 v220, v234, v235
    v_pk_mul_f32 v[236:237], v[236:237], v[246:247] op_sel_hi:[1,0]
    v_cvt_pk_bf16_f32 v221, v236, v237
    v_pk_mul_f32 v[232:233], v[232:233], v[246:247] op_sel_hi:[1,0]
    v_cvt_pk_bf16_f32 v222, v232, v233
    v_smfmac_f32_32x32x32_bf16 v[80:95], v[196:199], v[152:159], v7
    ds_read_b64_tr_b16 v[206:207], v9 offset:16608
    ds_write_b128 v240, v[216:219] offset:32768
    ds_write_b128 v240, v[220:223] offset:33792
    v_exp_f32 v172, v172
    v_exp_f32 v173, v173
    v_exp_f32 v174, v174
    v_exp_f32 v175, v175
    v_mfma_f32_32x32x16_bf16 v[128:143], v[184:187], v[24:27], 0
    v_exp_f32 v112, v112
    v_exp_f32 v113, v113
    v_exp_f32 v114, v114
    v_exp_f32 v115, v115
    v_mfma_f32_32x32x16_bf16 v[128:143], v[188:191], v[28:31], v[128:143]
    s_cbranch_vccnz L_prio_3
    s_setprio 0
L_prio_3:
    s_add_u32 m0, s52, 2048
    s_nop 0
    buffer_load_dwordx4 v3, s[28:31], s61 offen offset:0 lds
    v_exp_f32 v116, v116
    v_exp_f32 v117, v117
    v_exp_f32 v118, v118
    v_exp_f32 v119, v119
    v_smfmac_f32_32x32x32_bf16 v[96:111], v[192:195], v[160:167], v7
    s_mov_b64 exec, s[62:63]
    buffer_load_dwordx4 v3, s[28:31], s61 offen offset:1024 lds
    s_mov_b64 exec, -1
    v_exp_f32 v120, v120
    v_exp_f32 v121, v121
    v_exp_f32 v122, v122
    v_exp_f32 v123, v123
    v_smfmac_f32_32x32x32_bf16 v[96:111], v[196:199], v[168:175], v7
    v_exp_f32 v124, v124
    v_exp_f32 v125, v125
    v_exp_f32 v126, v126
    v_exp_f32 v127, v127
    v_mfma_f32_32x32x16_bf16 v[144:159], v[184:187], v[32:35], 0
    v_exp_f32 v128, v128
    v_exp_f32 v129, v129
    v_exp_f32 v130, v130
    v_exp_f32 v131, v131
    v_mfma_f32_32x32x16_bf16 v[144:159], v[188:191], v[36:39], v[144:159]
    s_waitcnt lgkmcnt(2)
    s_add_u32 m0, s52, 34816
    s_nop 0
    buffer_load_dwordx4 v3, s[28:31], s60 offen offset:0 lds
    v_exp_f32 v132, v132
    v_exp_f32 v133, v133
    v_exp_f32 v134, v134
    v_exp_f32 v135, v135
    v_smfmac_f32_32x32x32_bf16 v[48:63], v[200:203], v[112:119], v7
    s_mov_b64 exec, s[62:63]
    buffer_load_dwordx4 v3, s[28:31], s60 offen offset:1024 lds
    s_mov_b64 exec, -1
    v_exp_f32 v136, v136
    v_exp_f32 v137, v137
    v_exp_f32 v138, v138
    v_exp_f32 v139, v139
    v_smfmac_f32_32x32x32_bf16 v[48:63], v[204:207], v[120:127], v7
    v_exp_f32 v140, v140
    v_exp_f32 v141, v141
    v_exp_f32 v142, v142
    v_exp_f32 v143, v143
    v_mfma_f32_32x32x16_bf16 v[160:175], v[184:187], v[40:43], 0
    s_waitcnt vmcnt(7) lgkmcnt(0)
    s_barrier
    ds_read_b128 v[176:179], v4 offset:32768
    ds_read_b128 v[180:183], v4 offset:33792
    v_exp_f32 v144, v144
    v_exp_f32 v145, v145
    v_exp_f32 v146, v146
    v_exp_f32 v147, v147
    v_mfma_f32_32x32x16_bf16 v[160:175], v[188:191], v[44:47], v[160:175]
    s_cbranch_vccnz L_prio_4
    s_setprio 1
L_prio_4:
    v_exp_f32 v148, v148
    v_exp_f32 v149, v149
    v_exp_f32 v150, v150
    v_exp_f32 v151, v151
    v_smfmac_f32_32x32x32_bf16 v[64:79], v[200:203], v[128:135], v7
    ds_read_b64_tr_b16 v[192:193], v8 offset:32768
    v_exp_f32 v152, v152
    v_exp_f32 v153, v153
    v_exp_f32 v154, v154
    v_exp_f32 v155, v155
    v_smfmac_f32_32x32x32_bf16 v[64:79], v[204:207], v[136:143], v7
    s_waitcnt lgkmcnt(1)
    ds_read_b64_tr_b16 v[194:195], v8 offset:32992
    v_exp_f32 v156, v156
    v_exp_f32 v157, v157
    v_exp_f32 v158, v158
    v_exp_f32 v159, v159
    v_mfma_f32_32x32x16_bf16 v[112:127], v[176:179], v[16:19], 0
    v_exp_f32 v160, v160
    v_exp_f32 v161, v161
    v_exp_f32 v162, v162
    v_exp_f32 v163, v163
    v_mfma_f32_32x32x16_bf16 v[112:127], v[180:183], v[20:23], v[112:127]
    s_cbranch_vccnz L_prio_5
    s_setprio 0
L_prio_5:
    v_exp_f32 v164, v164
    v_exp_f32 v165, v165
    v_exp_f32 v166, v166
    v_exp_f32 v167, v167
    v_smfmac_f32_32x32x32_bf16 v[80:95], v[200:203], v[144:151], v7
    ds_read_b64_tr_b16 v[196:197], v9 offset:32768
    v_exp_f32 v168, v168
    v_exp_f32 v169, v169
    v_exp_f32 v170, v170
    v_exp_f32 v171, v171
    v_smfmac_f32_32x32x32_bf16 v[80:95], v[204:207], v[152:159], v7
    ds_read_b64_tr_b16 v[198:199], v9 offset:32992
    v_exp_f32 v172, v172
    v_exp_f32 v173, v173
    v_exp_f32 v174, v174
    v_exp_f32 v175, v175
    v_mfma_f32_32x32x16_bf16 v[128:143], v[176:179], v[24:27], 0
    s_waitcnt vmcnt(6)
    s_barrier
    s_cmp_lg_u32 s46, 0
    s_cbranch_scc1 L_published
    s_mov_b64 exec, 1
    buffer_store_byte v7, v0, s[40:43], s45 offen sc1
    s_mov_b64 exec, -1
L_published:
    v_exp_f32 v112, v112
    v_exp_f32 v113, v113
    v_exp_f32 v114, v114
    v_exp_f32 v115, v115
    s_waitcnt vmcnt(4)
    v_dot2_f32_bf16 v246, v224, v224, 0
    v_dot2_f32_bf16 v247, v225, v225, 0
    v_dot2_f32_bf16 v246, v226, v226, v246
    v_dot2_f32_bf16 v247, v227, v227, v247
    v_dot2_f32_bf16 v246, v228, v228, v246
    v_dot2_f32_bf16 v247, v229, v229, v247
    v_dot2_f32_bf16 v246, v230, v230, v246
    v_mfma_f32_32x32x16_bf16 v[128:143], v[180:183], v[28:31], v[128:143]
    s_cbranch_vccnz L_prio_6
    s_setprio 1
L_prio_6:
    v_exp_f32 v116, v116
    v_exp_f32 v117, v117
    v_exp_f32 v118, v118
    v_exp_f32 v119, v119
    v_add_f32 v246, v246, v247
    v_lshlrev_b32 v232, 16, v224
    v_and_b32 v233, 0xffff0000, v224
    v_add_f32_dpp v246, v246, v246 quad_perm:[1,0,3,2] row_mask:0xf bank_mask:0xf
    v_sqrt_f32 v246, v246
    v_lshlrev_b32 v234, 16, v225
    v_add_f32 v246, 0x358637bd, v246
    v_rcp_f32 v246, v246
    v_and_b32 v235, 0xffff0000, v225
    v_smfmac_f32_32x32x32_bf16 v[96:111], v[200:203], v[160:167], v7
    ds_read_b128 v[184:187], v4 offset:49152
    v_exp_f32 v120, v120
    v_exp_f32 v121, v121
    v_exp_f32 v122, v122
    v_exp_f32 v123, v123
    v_smfmac_f32_32x32x32_bf16 v[96:111], v[204:207], v[168:175], v7
    v_exp_f32 v124, v124
    v_exp_f32 v125, v125
    v_exp_f32 v126, v126
    v_exp_f32 v127, v127
    v_lshlrev_b32 v236, 16, v226
    v_and_b32 v237, 0xffff0000, v226
    v_pk_mul_f32 v[232:233], v[232:233], v[246:247] op_sel_hi:[1,0]
    v_cvt_pk_bf16_f32 v224, v232, v233
    v_lshlrev_b32 v232, 16, v227
    v_and_b32 v233, 0xffff0000, v227
    v_pk_mul_f32 v[234:235], v[234:235], v[246:247] op_sel_hi:[1,0]
    v_cvt_pk_bf16_f32 v225, v234, v235
    v_mfma_f32_32x32x16_bf16 v[144:159], v[176:179], v[32:35], 0
    v_exp_f32 v128, v128
    v_exp_f32 v129, v129
    v_exp_f32 v130, v130
    v_exp_f32 v131, v131
    v_lshlrev_b32 v234, 16, v228
    v_and_b32 v235, 0xffff0000, v228
    v_pk_mul_f32 v[236:237], v[236:237], v[246:247] op_sel_hi:[1,0]
    v_cvt_pk_bf16_f32 v226, v236, v237
    v_lshlrev_b32 v236, 16, v229
    v_and_b32 v237, 0xffff0000, v229
    v_pk_mul_f32 v[232:233], v[232:233], v[246:247] op_sel_hi:[1,0]
    v_cvt_pk_bf16_f32 v227, v232, v233
    v_mfma_f32_32x32x16_bf16 v[144:159], v[180:183], v[36:39], v[144:159]
    s_waitcnt lgkmcnt(1)
    v_exp_f32 v132, v132
    v_exp_f32 v133, v133
    v_exp_f32 v134, v134
    v_exp_f32 v135, v135
    v_smfmac_f32_32x32x32_bf16 v[48:63], v[192:195], v[112:119], v7
    ds_read_b128 v[188:191], v4 offset:50176
    v_exp_f32 v136, v136
    v_exp_f32 v137, v137
    v_exp_f32 v138, v138
    v_exp_f32 v139, v139
    v_lshlrev_b32 v232, 16, v230
    v_and_b32 v233, 0xffff0000, v230
    v_pk_mul_f32 v[234:235], v[234:235], v[246:247] op_sel_hi:[1,0]
    v_cvt_pk_bf16_f32 v228, v234, v235
    v_pk_mul_f32 v[236:237], v[236:237], v[246:247] op_sel_hi:[1,0]
    v_cvt_pk_bf16_f32 v229, v236, v237
    v_pk_mul_f32 v[232:233], v[232:233], v[246:247] op_sel_hi:[1,0]
    v_cvt_pk_bf16_f32 v230, v232, v233
    v_smfmac_f32_32x32x32_bf16 v[48:63], v[196:199], v[120:127], v7
    ds_write_b128 v241, v[224:227] offset:0
    ds_write_b128 v241, v[228:231] offset:1024
    v_exp_f32 v140, v140
    v_exp_f32 v141, v141
    v_exp_f32 v142, v142
    v_exp_f32 v143, v143
    v_mfma_f32_32x32x16_bf16 v[160:175], v[176:179], v[40:43], 0
    v_exp_f32 v144, v144
    v_exp_f32 v145, v145
    v_exp_f32 v146, v146
    v_exp_f32 v147, v147
    v_mfma_f32_32x32x16_bf16 v[160:175], v[180:183], v[44:47], v[160:175]
    v_exp_f32 v148, v148
    v_exp_f32 v149, v149
    v_exp_f32 v150, v150
    v_exp_f32 v151, v151
    v_smfmac_f32_32x32x32_bf16 v[64:79], v[192:195], v[128:135], v7
    s_waitcnt lgkmcnt(2)
    ds_read_b64_tr_b16 v[200:201], v8 offset:49152
    v_exp_f32 v152, v152
    v_exp_f32 v153, v153
    v_exp_f32 v154, v154
    v_exp_f32 v155, v155
    v_smfmac_f32_32x32x32_bf16 v[64:79], v[196:199], v[136:143], v7
    ds_read_b64_tr_b16 v[202:203], v8 offset:49376
    v_exp_f32 v156, v156
    v_exp_f32 v157, v157
    v_exp_f32 v158, v158
    v_exp_f32 v159, v159
    v_mfma_f32_32x32x16_bf16 v[112:127], v[184:187], v[16:19], 0
    v_exp_f32 v160, v160
    v_exp_f32 v161, v161
    v_exp_f32 v162, v162
    v_exp_f32 v163, v163
    v_mfma_f32_32x32x16_bf16 v[112:127], v[188:191], v[20:23], v[112:127]
    s_cbranch_vccnz L_prio_7
    s_setprio 0
L_prio_7:
    v_exp_f32 v164, v164
    v_exp_f32 v165, v165
    v_exp_f32 v166, v166
    v_exp_f32 v167, v167
    v_smfmac_f32_32x32x32_bf16 v[80:95], v[192:195], v[144:151], v7
    ds_read_b64_tr_b16 v[204:205], v9 offset:49152
    v_exp_f32 v168, v168
    v_exp_f32 v169, v169
    v_exp_f32 v170, v170
    v_exp_f32 v171, v171
    v_smfmac_f32_32x32x32_bf16 v[80:95], v[196:199], v[152:159], v7
    ds_read_b64_tr_b16 v[206:207], v9 offset:49376
    v_exp_f32 v172, v172
    v_exp_f32 v173, v173
    v_exp_f32 v174, v174
    v_exp_f32 v175, v175
    v_mfma_f32_32x32x16_bf16 v[128:143], v[184:187], v[24:27], 0
    v_exp_f32 v112, v112
    v_exp_f32 v113, v113
    v_exp_f32 v114, v114
    v_exp_f32 v115, v115
    v_mfma_f32_32x32x16_bf16 v[128:143], v[188:191], v[28:31], v[128:143]
    v_exp_f32 v116, v116
    v_exp_f32 v117, v117
    v_exp_f32 v118, v118
    v_exp_f32 v119, v119
    v_smfmac_f32_32x32x32_bf16 v[96:111], v[192:195], v[160:167], v7
    s_waitcnt vmcnt(1) lgkmcnt(0)
    s_cmp_eq_u32 s46, 0
    s_cbranch_scc1 L_wave0
    s_waitcnt vmcnt(0)
L_wave0:
    s_barrier
    v_exp_f32 v120, v120
    v_exp_f32 v121, v121
    v_exp_f32 v122, v122
    v_exp_f32 v123, v123
    v_smfmac_f32_32x32x32_bf16 v[96:111], v[196:199], v[168:175], v7
    ds_read_b128 v[176:179], v250 offset:0
    v_exp_f32 v124, v124
    v_exp_f32 v125, v125
    v_exp_f32 v126, v126
    v_exp_f32 v127, v127
    v_mfma_f32_32x32x16_bf16 v[144:159], v[184:187], v[32:35], 0
    v_exp_f32 v128, v128
    v_exp_f32 v129, v129
    v_exp_f32 v130, v130
    v_exp_f32 v131, v131
    v_mfma_f32_32x32x16_bf16 v[144:159], v[188:191], v[36:39], v[144:159]
    s_cbranch_vccnz L_prio_8
    s_setprio 1
L_prio_8:
    v_exp_f32 v132, v132
    v_exp_f32 v133, v133
    v_exp_f32 v134, v134
    v_exp_f32 v135, v135
    v_smfmac_f32_32x32x32_bf16 v[48:63], v[200:203], v[112:119], v7
    ds_read_b128 v[180:183], v250 offset:1024
    v_exp_f32 v136, v136
    v_exp_f32 v137, v137
    v_exp_f32 v138, v138
    v_exp_f32 v139, v139
    v_smfmac_f32_32x32x32_bf16 v[48:63], v[204:207], v[120:127], v7
    v_exp_f32 v140, v140
    v_exp_f32 v141, v141
    v_exp_f32 v142, v142
    v_exp_f32 v143, v143
    v_mfma_f32_32x32x16_bf16 v[160:175], v[184:187], v[40:43], 0
    v_exp_f32 v144, v144
    v_exp_f32 v145, v145
    v_exp_f32 v146, v146
    v_exp_f32 v147, v147
    v_mfma_f32_32x32x16_bf16 v[160:175], v[188:191], v[44:47], v[160:175]
    v_exp_f32 v148, v148
    v_exp_f32 v149, v149
    v_exp_f32 v150, v150
    v_exp_f32 v151, v151
    v_smfmac_f32_32x32x32_bf16 v[64:79], v[200:203], v[128:135], v7
    s_waitcnt lgkmcnt(0)
    ds_read_b64_tr_b16 v[192:193], v251 offset:0
    v_exp_f32 v152, v152
    v_exp_f32 v153, v153
    v_exp_f32 v154, v154
    v_exp_f32 v155, v155
    v_smfmac_f32_32x32x32_bf16 v[64:79], v[204:207], v[136:143], v7
    ds_read_b64_tr_b16 v[194:195], v251 offset:224
    v_exp_f32 v156, v156
    v_exp_f32 v157, v157
    v_exp_f32 v158, v158
    v_exp_f32 v159, v159
    v_mfma_f32_32x32x16_bf16 v[112:127], v[176:179], v[16:19], 0
    v_exp_f32 v160, v160
    v_exp_f32 v161, v161
    v_exp_f32 v162, v162
    v_exp_f32 v163, v163
    v_mfma_f32_32x32x16_bf16 v[112:127], v[180:183], v[20:23], v[112:127]
    v_exp_f32 v164, v164
    v_exp_f32 v165, v165
    v_exp_f32 v166, v166
    v_exp_f32 v167, v167
    v_smfmac_f32_32x32x32_bf16 v[80:95], v[200:203], v[144:151], v7
    ds_read_b64_tr_b16 v[196:197], v252 offset:0
    v_exp_f32 v168, v168
    v_exp_f32 v169, v169
    v_exp_f32 v170, v170
    v_exp_f32 v171, v171
    v_smfmac_f32_32x32x32_bf16 v[80:95], v[204:207], v[152:159], v7
    ds_read_b64_tr_b16 v[198:199], v252 offset:224
    v_exp_f32 v172, v172
    v_exp_f32 v173, v173
    v_exp_f32 v174, v174
    v_exp_f32 v175, v175
.p2align 6
L_loop:
    v_mfma_f32_32x32x16_bf16 v[128:143], v[176:179], v[24:27], 0
    v_exp_f32 v112, v112
    v_exp_f32 v113, v113
    v_exp_f32 v114, v114
    v_exp_f32 v115, v115
    v_mfma_f32_32x32x16_bf16 v[128:143], v[180:183], v[28:31], v[128:143]
    v_exp_f32 v116, v116
    v_exp_f32 v117, v117
    v_exp_f32 v118, v118
    v_exp_f32 v119, v119
    v_smfmac_f32_32x32x32_bf16 v[96:111], v[200:203], v[160:167], v7
    v_exp_f32 v120, v120
    v_exp_f32 v121, v121
    v_exp_f32 v122, v122
    v_exp_f32 v123, v123
    v_smfmac_f32_32x32x32_bf16 v[96:111], v[204:207], v[168:175], v7
    ds_read_b128 v[184:187], v250 offset:16384
    v_exp_f32 v124, v124
    v_exp_f32 v125, v125
    v_exp_f32 v126, v126
    v_exp_f32 v127, v127
    v_mfma_f32_32x32x16_bf16 v[144:159], v[176:179], v[32:35], 0
    v_exp_f32 v128, v128
    v_exp_f32 v129, v129
    v_exp_f32 v130, v130
    v_exp_f32 v131, v131
    v_mfma_f32_32x32x16_bf16 v[144:159], v[180:183], v[36:39], v[144:159]
    s_waitcnt lgkmcnt(1)
    v_exp_f32 v132, v132
    v_exp_f32 v133, v133
    v_exp_f32 v134, v134
    v_exp_f32 v135, v135
    v_smfmac_f32_32x32x32_bf16 v[48:63], v[192:195], v[112:119], v7
    v_exp_f32 v136, v136
    v_exp_f32 v137, v137
    v_exp_f32 v138, v138
    v_exp_f32 v139, v139
    v_smfmac_f32_32x32x32_bf16 v[48:63], v[196:199], v[120:127], v7
    ds_read_b128 v[188:191], v250 offset:17408
    v_exp_f32 v140, v140
    v_exp_f32 v141, v141
    v_exp_f32 v142, v142
    v_exp_f32 v143, v143
    v_mfma_f32_32x32x16_bf16 v[160:175], v[176:179], v[40:43], 0
    v_exp_f32 v144, v144
    v_exp_f32 v145, v145
    v_exp_f32 v146, v146
    v_exp_f32 v147, v147
    v_mfma_f32_32x32x16_bf16 v[160:175], v[180:183], v[44:47], v[160:175]
    v_exp_f32 v148, v148
    v_exp_f32 v149, v149
    v_exp_f32 v150, v150
    v_exp_f32 v151, v151
    v_smfmac_f32_32x32x32_bf16 v[64:79], v[192:195], v[128:135], v7
    s_cmp_lg_u32 s54, 3
    s_cbranch_scc1 L_noflags
    buffer_load_dwordx4 v[10:13], off, s[40:43], 0 sc1
L_noflags:
    s_waitcnt lgkmcnt(0)
    ds_read_b64_tr_b16 v[200:201], v251 offset:16384
    v_exp_f32 v152, v152
    v_exp_f32 v153, v153
    v_exp_f32 v154, v154
    v_exp_f32 v155, v155
    v_smfmac_f32_32x32x32_bf16 v[64:79], v[196:199], v[136:143], v7
    s_cmp_ge_u32 s49, s18
    s_addc_u32 s19, s49, 0
    ds_read_b64_tr_b16 v[202:203], v251 offset:16608
    v_exp_f32 v156, v156
    v_exp_f32 v157, v157
    v_exp_f32 v158, v158
    v_exp_f32 v159, v159
    v_mfma_f32_32x32x16_bf16 v[112:127], v[184:187], v[16:19], 0
    s_add_u32 s49, s49, 1
    v_exp_f32 v160, v160
    v_exp_f32 v161, v161
    v_exp_f32 v162, v162
    v_exp_f32 v163, v163
    v_mfma_f32_32x32x16_bf16 v[112:127], v[188:191], v[20:23], v[112:127]
    v_exp_f32 v164, v164
    v_exp_f32 v165, v165
    v_exp_f32 v166, v166
    v_exp_f32 v167, v167
    v_smfmac_f32_32x32x32_bf16 v[80:95], v[192:195], v[144:151], v7
    ds_read_b64_tr_b16 v[204:205], v252 offset:16384
    v_exp_f32 v168, v168
    v_exp_f32 v169, v169
    v_exp_f32 v170, v170
    v_exp_f32 v171, v171
    v_smfmac_f32_32x32x32_bf16 v[80:95], v[196:199], v[152:159], v7
    s_lshl_b32 s50, s19, 14
    s_add_u32 s50, s50, s55
    ds_read_b64_tr_b16 v[206:207], v252 offset:16608
    v_exp_f32 v172, v172
    v_exp_f32 v173, v173
    v_exp_f32 v174, v174
    v_exp_f32 v175, v175
    v_mfma_f32_32x32x16_bf16 v[128:143], v[184:187], v[24:27], 0
    s_cmp_lg_u32 s54, 3
    s_cbranch_scc1 L_ready
    s_mov_b32 s64, 0
L_poll:
    s_waitcnt vmcnt(0)
    v_and_b32 v10, v10, v11
    v_and_b32 v12, v12, v13
    v_and_b32 v10, v10, v12
    s_add_u32 s64, s64, 1
    v_readfirstlane_b32 s65, v10
    s_cmp_eq_u32 s65, 0xdddddddd
    s_cbranch_scc1 L_ready
    buffer_load_dwordx4 v[10:13], off, s[40:43], 0 sc1
    s_cmp_lt_u32 s64, 65536
    s_cbranch_scc1 L_poll
    s_waitcnt vmcnt(0)
    s_mov_b32 s59, 1
L_ready:
    s_add_u32 m0, s52, 65536
    v_exp_f32 v112, v112
    v_exp_f32 v113, v113
    v_exp_f32 v114, v114
    v_exp_f32 v115, v115
    v_mfma_f32_32x32x16_bf16 v[128:143], v[188:191], v[28:31], v[128:143]
    buffer_load_dwordx4 v3, s[36:39], s50 offen offset:0 sc1 lds
    v_exp_f32 v116, v116
    v_exp_f32 v117, v117
    v_exp_f32 v118, v118
    v_exp_f32 v119, v119
    v_smfmac_f32_32x32x32_bf16 v[96:111], v[192:195], v[160:167], v7
    buffer_load_dwordx4 v3, s[36:39], s50 offen offset:1024 sc1 lds
    v_exp_f32 v120, v120
    v_exp_f32 v121, v121
    v_exp_f32 v122, v122
    v_exp_f32 v123, v123
    v_smfmac_f32_32x32x32_bf16 v[96:111], v[196:199], v[168:175], v7
    s_mul_i32 s51, s19, 14336
    s_add_u32 s51, s51, s56
    s_cmp_ge_u32 s49, s18
    s_addc_u32 s19, s49, 0
    ds_read_b128 v[176:179], v250 offset:32768
    v_exp_f32 v124, v124
    v_exp_f32 v125, v125
    v_exp_f32 v126, v126
    v_exp_f32 v127, v127
    v_mfma_f32_32x32x16_bf16 v[144:159], v[184:187], v[32:35], 0
    s_add_u32 m0, s52, 67584
    s_add_u32 s49, s49, 1
    v_exp_f32 v128, v128
    v_exp_f32 v129, v129
    v_exp_f32 v130, v130
    v_exp_f32 v131, v131
    v_mfma_f32_32x32x16_bf16 v[144:159], v[188:191], v[36:39], v[144:159]
    buffer_load_dwordx4 v3, s[28:31], s51 offen offset:0 lds
    s_waitcnt lgkmcnt(1)
    v_exp_f32 v132, v132
    v_exp_f32 v133, v133
    v_exp_f32 v134, v134
    v_exp_f32 v135, v135
    v_smfmac_f32_32x32x32_bf16 v[48:63], v[200:203], v[112:119], v7
    s_mov_b64 exec, s[62:63]
    buffer_load_dwordx4 v3, s[28:31], s51 offen offset:1024 lds
    s_mov_b64 exec, -1
    v_exp_f32 v136, v136
    v_exp_f32 v137, v137
    v_exp_f32 v138, v138
    v_exp_f32 v139, v139
    v_smfmac_f32_32x32x32_bf16 v[48:63], v[204:207], v[120:127], v7
    s_lshl_b32 s50, s19, 14
    s_add_u32 s50, s50, s55
    ds_read_b128 v[180:183], v250 offset:33792
    v_exp_f32 v140, v140
    v_exp_f32 v141, v141
    v_exp_f32 v142, v142
    v_exp_f32 v143, v143
    v_mfma_f32_32x32x16_bf16 v[160:175], v[184:187], v[40:43], 0
    s_add_u32 m0, s52, 98304
    v_exp_f32 v144, v144
    v_exp_f32 v145, v145
    v_exp_f32 v146, v146
    v_exp_f32 v147, v147
    v_mfma_f32_32x32x16_bf16 v[160:175], v[188:191], v[44:47], v[160:175]
    buffer_load_dwordx4 v3, s[36:39], s50 offen offset:0 sc1 lds
    v_exp_f32 v148, v148
    v_exp_f32 v149, v149
    v_exp_f32 v150, v150
    v_exp_f32 v151, v151
    v_smfmac_f32_32x32x32_bf16 v[64:79], v[200:203], v[128:135], v7
    buffer_load_dwordx4 v3, s[36:39], s50 offen offset:1024 sc1 lds
    s_waitcnt lgkmcnt(0)
    ds_read_b64_tr_b16 v[192:193], v251 offset:32768
    v_exp_f32 v152, v152
    v_exp_f32 v153, v153
    v_exp_f32 v154, v154
    v_exp_f32 v155, v155
    v_smfmac_f32_32x32x32_bf16 v[64:79], v[204:207], v[136:143], v7
    s_mul_i32 s51, s19, 14336
    s_add_u32 s51, s51, s56
    ds_read_b64_tr_b16 v[194:195], v251 offset:32992
    v_exp_f32 v156, v156
    v_exp_f32 v157, v157
    v_exp_f32 v158, v158
    v_exp_f32 v159, v159
    v_mfma_f32_32x32x16_bf16 v[112:127], v[176:179], v[16:19], 0
    s_add_u32 m0, s52, 100352
    v_exp_f32 v160, v160
    v_exp_f32 v161, v161
    v_exp_f32 v162, v162
    v_exp_f32 v163, v163
    v_mfma_f32_32x32x16_bf16 v[112:127], v[180:183], v[20:23], v[112:127]
    buffer_load_dwordx4 v3, s[28:31], s51 offen offset:0 lds
    v_exp_f32 v164, v164
    v_exp_f32 v165, v165
    v_exp_f32 v166, v166
    v_exp_f32 v167, v167
    v_smfmac_f32_32x32x32_bf16 v[80:95], v[200:203], v[144:151], v7
    s_mov_b64 exec, s[62:63]
    buffer_load_dwordx4 v3, s[28:31], s51 offen offset:1024 lds
    s_mov_b64 exec, -1
    ds_read_b64_tr_b16 v[196:197], v252 offset:32768
    v_exp_f32 v168, v168
    v_exp_f32 v169, v169
    v_exp_f32 v170, v170
    v_exp_f32 v171, v171
    v_smfmac_f32_32x32x32_bf16 v[80:95], v[204:207], v[152:159], v7
    ds_read_b64_tr_b16 v[198:199], v252 offset:32992
    v_exp_f32 v172, v172
    v_exp_f32 v173, v173
    v_exp_f32 v174, v174
    v_exp_f32 v175, v175
    v_mfma_f32_32x32x16_bf16 v[128:143], v[176:179], v[24:27], 0
    v_exp_f32 v112, v112
    v_exp_f32 v113, v113
    v_exp_f32 v114, v114
    v_exp_f32 v115, v115
    v_mfma_f32_32x32x16_bf16 v[128:143], v[180:183], v[28:31], v[128:143]
    v_exp_f32 v116, v116
    v_exp_f32 v117, v117
    v_exp_f32 v118, v118
    v_exp_f32 v119, v119
    v_smfmac_f32_32x32x32_bf16 v[96:111], v[200:203], v[160:167], v7
    v_exp_f32 v120, v120
    v_exp_f32 v121, v121
    v_exp_f32 v122, v122
    v_exp_f32 v123, v123
    v_smfmac_f32_32x32x32_bf16 v[96:111], v[204:207], v[168:175], v7
    ds_read_b128 v[184:187], v250 offset:49152
    v_exp_f32 v124, v124
    v_exp_f32 v125, v125
    v_exp_f32 v126, v126
    v_exp_f32 v127, v127
    v_mfma_f32_32x32x16_bf16 v[144:159], v[176:179], v[32:35], 0
    v_exp_f32 v128, v128
    v_exp_f32 v129, v129
    v_exp_f32 v130, v130
    v_exp_f32 v131, v131
    v_mfma_f32_32x32x16_bf16 v[144:159], v[180:183], v[36:39], v[144:159]
    s_waitcnt lgkmcnt(1)
    v_exp_f32 v132, v132
    v_exp_f32 v133, v133
    v_exp_f32 v134, v134
    v_exp_f32 v135, v135
    v_smfmac_f32_32x32x32_bf16 v[48:63], v[192:195], v[112:119], v7
    v_exp_f32 v136, v136
    v_exp_f32 v137, v137
    v_exp_f32 v138, v138
    v_exp_f32 v139, v139
    v_smfmac_f32_32x32x32_bf16 v[48:63], v[196:199], v[120:127], v7
    ds_read_b128 v[188:191], v250 offset:50176
    v_exp_f32 v140, v140
    v_exp_f32 v141, v141
    v_exp_f32 v142, v142
    v_exp_f32 v143, v143
    v_mfma_f32_32x32x16_bf16 v[160:175], v[176:179], v[40:43], 0
    v_exp_f32 v144, v144
    v_exp_f32 v145, v145
    v_exp_f32 v146, v146
    v_exp_f32 v147, v147
    v_mfma_f32_32x32x16_bf16 v[160:175], v[180:183], v[44:47], v[160:175]
    s_cbranch_vccnz L_prio_9
    s_setprio 0
L_prio_9:
    v_exp_f32 v148, v148
    v_exp_f32 v149, v149
    v_exp_f32 v150, v150
    v_exp_f32 v151, v151
    v_smfmac_f32_32x32x32_bf16 v[64:79], v[192:195], v[128:135], v7
    s_waitcnt lgkmcnt(0)
    ds_read_b64_tr_b16 v[200:201], v251 offset:49152
    v_exp_f32 v152, v152
    v_exp_f32 v153, v153
    v_exp_f32 v154, v154
    v_exp_f32 v155, v155
    v_smfmac_f32_32x32x32_bf16 v[64:79], v[196:199], v[136:143], v7
    ds_read_b64_tr_b16 v[202:203], v251 offset:49376
    v_exp_f32 v156, v156
    v_exp_f32 v157, v157
    v_exp_f32 v158, v158
    v_exp_f32 v159, v159
    v_mfma_f32_32x32x16_bf16 v[112:127], v[184:187], v[16:19], 0
    v_exp_f32 v160, v160
    v_exp_f32 v161, v161
    v_exp_f32 v162, v162
    v_exp_f32 v163, v163
    v_mfma_f32_32x32x16_bf16 v[112:127], v[188:191], v[20:23], v[112:127]
    v_exp_f32 v164, v164
    v_exp_f32 v165, v165
    v_exp_f32 v166, v166
    v_exp_f32 v167, v167
    v_smfmac_f32_32x32x32_bf16 v[80:95], v[192:195], v[144:151], v7
    ds_read_b64_tr_b16 v[204:205], v252 offset:49152
    v_exp_f32 v168, v168
    v_exp_f32 v169, v169
    v_exp_f32 v170, v170
    v_exp_f32 v171, v171
    v_smfmac_f32_32x32x32_bf16 v[80:95], v[196:199], v[152:159], v7
    ds_read_b64_tr_b16 v[206:207], v252 offset:49376
    v_exp_f32 v172, v172
    v_exp_f32 v173, v173
    v_exp_f32 v174, v174
    v_exp_f32 v175, v175
    v_mfma_f32_32x32x16_bf16 v[128:143], v[184:187], v[24:27], 0
    v_exp_f32 v112, v112
    v_exp_f32 v113, v113
    v_exp_f32 v114, v114
    v_exp_f32 v115, v115
    v_mfma_f32_32x32x16_bf16 v[128:143], v[188:191], v[28:31], v[128:143]
    v_exp_f32 v116, v116
    v_exp_f32 v117, v117
    v_exp_f32 v118, v118
    v_exp_f32 v119, v119
    v_smfmac_f32_32x32x32_bf16 v[96:111], v[192:195], v[160:167], v7
    s_waitcnt vmcnt(0) lgkmcnt(0)
    s_barrier
    v_exp_f32 v120, v120
    v_exp_f32 v121, v121
    v_exp_f32 v122, v122
    v_exp_f32 v123, v123
    v_smfmac_f32_32x32x32_bf16 v[96:111], v[196:199], v[168:175], v7
    ds_read_b128 v[176:179], v4 offset:0
    v_exp_f32 v124, v124
    v_exp_f32 v125, v125
    v_exp_f32 v126, v126
    v_exp_f32 v127, v127
    v_mfma_f32_32x32x16_bf16 v[144:159], v[184:187], v[32:35], 0
    v_exp_f32 v128, v128
    v_exp_f32 v129, v129
    v_exp_f32 v130, v130
    v_exp_f32 v131, v131
    v_mfma_f32_32x32x16_bf16 v[144:159], v[188:191], v[36:39], v[144:159]
    s_cbranch_vccnz L_prio_10
    s_setprio 1
L_prio_10:
    v_exp_f32 v132, v132
    v_exp_f32 v133, v133
    v_exp_f32 v134, v134
    v_exp_f32 v135, v135
    v_smfmac_f32_32x32x32_bf16 v[48:63], v[200:203], v[112:119], v7
    v_exp_f32 v136, v136
    v_exp_f32 v137, v137
    v_exp_f32 v138, v138
    v_exp_f32 v139, v139
    v_smfmac_f32_32x32x32_bf16 v[48:63], v[204:207], v[120:127], v7
    ds_read_b128 v[180:183], v4 offset:1024
    v_exp_f32 v140, v140
    v_exp_f32 v141, v141
    v_exp_f32 v142, v142
    v_exp_f32 v143, v143
    v_mfma_f32_32x32x16_bf16 v[160:175], v[184:187], v[40:43], 0
    v_exp_f32 v144, v144
    v_exp_f32 v145, v145
    v_exp_f32 v146, v146
    v_exp_f32 v147, v147
    v_mfma_f32_32x32x16_bf16 v[160:175], v[188:191], v[44:47], v[160:175]
    v_exp_f32 v148, v148
    v_exp_f32 v149, v149
    v_exp_f32 v150, v150
    v_exp_f32 v151, v151
    v_smfmac_f32_32x32x32_bf16 v[64:79], v[200:203], v[128:135], v7
    s_waitcnt lgkmcnt(0)
    ds_read_b64_tr_b16 v[192:193], v8 offset:0
    v_exp_f32 v152, v152
    v_exp_f32 v153, v153
    v_exp_f32 v154, v154
    v_exp_f32 v155, v155
    v_smfmac_f32_32x32x32_bf16 v[64:79], v[204:207], v[136:143], v7
    ds_read_b64_tr_b16 v[194:195], v8 offset:224
    v_exp_f32 v156, v156
    v_exp_f32 v157, v157
    v_exp_f32 v158, v158
    v_exp_f32 v159, v159
    v_mfma_f32_32x32x16_bf16 v[112:127], v[176:179], v[16:19], 0
    v_exp_f32 v160, v160
    v_exp_f32 v161, v161
    v_exp_f32 v162, v162
    v_exp_f32 v163, v163
    v_mfma_f32_32x32x16_bf16 v[112:127], v[180:183], v[20:23], v[112:127]
    v_exp_f32 v164, v164
    v_exp_f32 v165, v165
    v_exp_f32 v166, v166
    v_exp_f32 v167, v167
    v_smfmac_f32_32x32x32_bf16 v[80:95], v[200:203], v[144:151], v7
    ds_read_b64_tr_b16 v[196:197], v9 offset:0
    v_exp_f32 v168, v168
    v_exp_f32 v169, v169
    v_exp_f32 v170, v170
    v_exp_f32 v171, v171
    v_smfmac_f32_32x32x32_bf16 v[80:95], v[204:207], v[152:159], v7
    ds_read_b64_tr_b16 v[198:199], v9 offset:224
    v_exp_f32 v172, v172
    v_exp_f32 v173, v173
    v_exp_f32 v174, v174
    v_exp_f32 v175, v175
    v_mfma_f32_32x32x16_bf16 v[128:143], v[176:179], v[24:27], 0
    v_exp_f32 v112, v112
    v_exp_f32 v113, v113
    v_exp_f32 v114, v114
    v_exp_f32 v115, v115
    v_mfma_f32_32x32x16_bf16 v[128:143], v[180:183], v[28:31], v[128:143]
    v_exp_f32 v116, v116
    v_exp_f32 v117, v117
    v_exp_f32 v118, v118
    v_exp_f32 v119, v119
    v_smfmac_f32_32x32x32_bf16 v[96:111], v[200:203], v[160:167], v7
    v_exp_f32 v120, v120
    v_exp_f32 v121, v121
    v_exp_f32 v122, v122
    v_exp_f32 v123, v123
    v_smfmac_f32_32x32x32_bf16 v[96:111], v[204:207], v[168:175], v7
    ds_read_b128 v[184:187], v4 offset:16384
    v_exp_f32 v124, v124
    v_exp_f32 v125, v125
    v_exp_f32 v126, v126
    v_exp_f32 v127, v127
    v_mfma_f32_32x32x16_bf16 v[144:159], v[176:179], v[32:35], 0
    v_exp_f32 v128, v128
    v_exp_f32 v129, v129
    v_exp_f32 v130, v130
    v_exp_f32 v131, v131
    v_mfma_f32_32x32x16_bf16 v[144:159], v[180:183], v[36:39], v[144:159]
    s_waitcnt lgkmcnt(1)
    v_exp_f32 v132, v132
    v_exp_f32 v133, v133
    v_exp_f32 v134, v134
    v_exp_f32 v135, v135
    v_smfmac_f32_32x32x32_bf16 v[48:63], v[192:195], v[112:119], v7
    v_exp_f32 v136, v136
    v_exp_f32 v137, v137
    v_exp_f32 v138, v138
    v_exp_f32 v139, v139
    v_smfmac_f32_32x32x32_bf16 v[48:63], v[196:199], v[120:127], v7
    ds_read_b128 v[188:191], v4 offset:17408
    v_exp_f32 v140, v140
    v_exp_f32 v141, v141
    v_exp_f32 v142, v142
    v_exp_f32 v143, v143
    v_mfma_f32_32x32x16_bf16 v[160:175], v[176:179], v[40:43], 0
    v_exp_f32 v144, v144
    v_exp_f32 v145, v145
    v_exp_f32 v146, v146
    v_exp_f32 v147, v147
    v_mfma_f32_32x32x16_bf16 v[160:175], v[180:183], v[44:47], v[160:175]
    v_exp_f32 v148, v148
    v_exp_f32 v149, v149
    v_exp_f32 v150, v150
    v_exp_f32 v151, v151
    v_smfmac_f32_32x32x32_bf16 v[64:79], v[192:195], v[128:135], v7
    s_waitcnt lgkmcnt(0)
    ds_read_b64_tr_b16 v[200:201], v8 offset:16384
    v_exp_f32 v152, v152
    v_exp_f32 v153, v153
    v_exp_f32 v154, v154
    v_exp_f32 v155, v155
    v_smfmac_f32_32x32x32_bf16 v[64:79], v[196:199], v[136:143], v7
    s_cmp_ge_u32 s49, s18
    s_addc_u32 s19, s49, 0
    ds_read_b64_tr_b16 v[202:203], v8 offset:16608
    v_exp_f32 v156, v156
    v_exp_f32 v157, v157
    v_exp_f32 v158, v158
    v_exp_f32 v159, v159
    v_mfma_f32_32x32x16_bf16 v[112:127], v[184:187], v[16:19], 0
    s_add_u32 s49, s49, 1
    v_exp_f32 v160, v160
    v_exp_f32 v161, v161
    v_exp_f32 v162, v162
    v_exp_f32 v163, v163
    v_mfma_f32_32x32x16_bf16 v[112:127], v[188:191], v[20:23], v[112:127]
    v_exp_f32 v164, v164
    v_exp_f32 v165, v165
    v_exp_f32 v166, v166
    v_exp_f32 v167, v167
    v_smfmac_f32_32x32x32_bf16 v[80:95], v[192:195], v[144:151], v7
    ds_read_b64_tr_b16 v[204:205], v9 offset:16384
    v_exp_f32 v168, v168
    v_exp_f32 v169, v169
    v_exp_f32 v170, v170
    v_exp_f32 v171, v171
    v_smfmac_f32_32x32x32_bf16 v[80:95], v[196:199], v[152:159], v7
    s_lshl_b32 s50, s19, 14
    s_add_u32 s50, s50, s55
    ds_read_b64_tr_b16 v[206:207], v9 offset:16608
    v_exp_f32 v172, v172
    v_exp_f32 v173, v173
    v_exp_f32 v174, v174
    v_exp_f32 v175, v175
    v_mfma_f32_32x32x16_bf16 v[128:143], v[184:187], v[24:27], 0
    s_add_u32 m0, s52, 0
    v_exp_f32 v112, v112
    v_exp_f32 v113, v113
    v_exp_f32 v114, v114
    v_exp_f32 v115, v115
    v_mfma_f32_32x32x16_bf16 v[128:143], v[188:191], v[28:31], v[128:143]
    buffer_load_dwordx4 v3, s[36:39], s50 offen offset:0 sc1 lds
    v_exp_f32 v116, v116
    v_exp_f32 v117, v117
    v_exp_f32 v118, v118
    v_exp_f32 v119, v119
    v_smfmac_f32_32x32x32_bf16 v[96:111], v[192:195], v[160:167], v7
    buffer_load_dwordx4 v3, s[36:39], s50 offen offset:1024 sc1 lds
    v_exp_f32 v120, v120
    v_exp_f32 v121, v121
    v_exp_f32 v122, v122
    v_exp_f32 v123, v123
    v_smfmac_f32_32x32x32_bf16 v[96:111], v[196:199], v[168:175], v7
    s_mul_i32 s51, s19, 14336
    s_add_u32 s51, s51, s56
    s_cmp_ge_u32 s49, s18
    s_addc_u32 s19, s49, 0
    ds_read_b128 v[176:179], v4 offset:32768
    v_exp_f32 v124, v124
    v_exp_f32 v125, v125
    v_exp_f32 v126, v126
    v_exp_f32 v127, v127
    v_mfma_f32_32x32x16_bf16 v[144:159], v[184:187], v[32:35], 0
    s_add_u32 m0, s52, 2048
    s_add_u32 s49, s49, 1
    v_exp_f32 v128, v128
    v_exp_f32 v129, v129
    v_exp_f32 v130, v130
    v_exp_f32 v131, v131
    v_mfma_f32_32x32x16_bf16 v[144:159], v[188:191], v[36:39], v[144:159]
    buffer_load_dwordx4 v3, s[28:31], s51 offen offset:0 lds
    s_waitcnt lgkmcnt(1)
    v_exp_f32 v132, v132
    v_exp_f32 v133, v133
    v_exp_f32 v134, v134
    v_exp_f32 v135, v135
    v_smfmac_f32_32x32x32_bf16 v[48:63], v[200:203], v[112:119], v7
    s_mov_b64 exec, s[62:63]
    buffer_load_dwordx4 v3, s[28:31], s51 offen offset:1024 lds
    s_mov_b64 exec, -1
    v_exp_f32 v136, v136
    v_exp_f32 v137, v137
    v_exp_f32 v138, v138
    v_exp_f32 v139, v139
    v_smfmac_f32_32x32x32_bf16 v[48:63], v[204:207], v[120:127], v7
    s_lshl_b32 s50, s19, 14
    s_add_u32 s50, s50, s55
    ds_read_b128 v[180:183], v4 offset:33792
    v_exp_f32 v140, v140
    v_exp_f32 v141, v141
    v_exp_f32 v142, v142
    v_exp_f32 v143, v143
    v_mfma_f32_32x32x16_bf16 v[160:175], v[184:187], v[40:43], 0
    s_add_u32 m0, s52, 32768
    v_exp_f32 v144, v144
    v_exp_f32 v145, v145
    v_exp_f32 v146, v146
    v_exp_f32 v147, v147
    v_mfma_f32_32x32x16_bf16 v[160:175], v[188:191], v[44:47], v[160:175]
    buffer_load_dwordx4 v3, s[36:39], s50 offen offset:0 sc1 lds
    v_exp_f32 v148, v148
    v_exp_f32 v149, v149
    v_exp_f32 v150, v150
    v_exp_f32 v151, v151
    v_smfmac_f32_32x32x32_bf16 v[64:79], v[200:203], v[128:135], v7
    buffer_load_dwordx4 v3, s[36:39], s50 offen offset:1024 sc1 lds
    s_waitcnt lgkmcnt(0)
    ds_read_b64_tr_b16 v[192:193], v8 offset:32768
    v_exp_f32 v152, v152
    v_exp_f32 v153, v153
    v_exp_f32 v154, v154
    v_exp_f32 v155, v155
    v_smfmac_f32_32x32x32_bf16 v[64:79], v[204:207], v[136:143], v7
    s_mul_i32 s51, s19, 14336
    s_add_u32 s51, s51, s56
    ds_read_b64_tr_b16 v[194:195], v8 offset:32992
    v_exp_f32 v156, v156
    v_exp_f32 v157, v157
    v_exp_f32 v158, v158
    v_exp_f32 v159, v159
    v_mfma_f32_32x32x16_bf16 v[112:127], v[176:179], v[16:19], 0
    s_add_u32 m0, s52, 34816
    v_exp_f32 v160, v160
    v_exp_f32 v161, v161
    v_exp_f32 v162, v162
    v_exp_f32 v163, v163
    v_mfma_f32_32x32x16_bf16 v[112:127], v[180:183], v[20:23], v[112:127]
    buffer_load_dwordx4 v3, s[28:31], s51 offen offset:0 lds
    v_exp_f32 v164, v164
    v_exp_f32 v165, v165
    v_exp_f32 v166, v166
    v_exp_f32 v167, v167
    v_smfmac_f32_32x32x32_bf16 v[80:95], v[200:203], v[144:151], v7
    s_mov_b64 exec, s[62:63]
    buffer_load_dwordx4 v3, s[28:31], s51 offen offset:1024 lds
    s_mov_b64 exec, -1
    ds_read_b64_tr_b16 v[196:197], v9 offset:32768
    v_exp_f32 v168, v168
    v_exp_f32 v169, v169
    v_exp_f32 v170, v170
    v_exp_f32 v171, v171
    v_smfmac_f32_32x32x32_bf16 v[80:95], v[204:207], v[152:159], v7
    ds_read_b64_tr_b16 v[198:199], v9 offset:32992
    v_exp_f32 v172, v172
    v_exp_f32 v173, v173
    v_exp_f32 v174, v174
    v_exp_f32 v175, v175
    v_mfma_f32_32x32x16_bf16 v[128:143], v[176:179], v[24:27], 0
    v_exp_f32 v112, v112
    v_exp_f32 v113, v113
    v_exp_f32 v114, v114
    v_exp_f32 v115, v115
    v_mfma_f32_32x32x16_bf16 v[128:143], v[180:183], v[28:31], v[128:143]
    v_exp_f32 v116, v116
    v_exp_f32 v117, v117
    v_exp_f32 v118, v118
    v_exp_f32 v119, v119
    v_smfmac_f32_32x32x32_bf16 v[96:111], v[200:203], v[160:167], v7
    v_exp_f32 v120, v120
    v_exp_f32 v121, v121
    v_exp_f32 v122, v122
    v_exp_f32 v123, v123
    v_smfmac_f32_32x32x32_bf16 v[96:111], v[204:207], v[168:175], v7
    ds_read_b128 v[184:187], v4 offset:49152
    v_exp_f32 v124, v124
    v_exp_f32 v125, v125
    v_exp_f32 v126, v126
    v_exp_f32 v127, v127
    v_mfma_f32_32x32x16_bf16 v[144:159], v[176:179], v[32:35], 0
    v_exp_f32 v128, v128
    v_exp_f32 v129, v129
    v_exp_f32 v130, v130
    v_exp_f32 v131, v131
    v_mfma_f32_32x32x16_bf16 v[144:159], v[180:183], v[36:39], v[144:159]
    s_waitcnt lgkmcnt(1)
    v_exp_f32 v132, v132
    v_exp_f32 v133, v133
    v_exp_f32 v134, v134
    v_exp_f32 v135, v135
    v_smfmac_f32_32x32x32_bf16 v[48:63], v[192:195], v[112:119], v7
    v_exp_f32 v136, v136
    v_exp_f32 v137, v137
    v_exp_f32 v138, v138
    v_exp_f32 v139, v139
    v_smfmac_f32_32x32x32_bf16 v[48:63], v[196:199], v[120:127], v7
    ds_read_b128 v[188:191], v4 offset:50176
    v_exp_f32 v140, v140
    v_exp_f32 v141, v141
    v_exp_f32 v142, v142
    v_exp_f32 v143, v143
    v_mfma_f32_32x32x16_bf16 v[160:175], v[176:179], v[40:43], 0
    v_exp_f32 v144, v144
    v_exp_f32 v145, v145
    v_exp_f32 v146, v146
    v_exp_f32 v147, v147
    v_mfma_f32_32x32x16_bf16 v[160:175], v[180:183], v[44:47], v[160:175]
    s_cbranch_vccnz L_prio_11
    s_setprio 0
L_prio_11:
    v_exp_f32 v148, v148
    v_exp_f32 v149, v149
    v_exp_f32 v150, v150
    v_exp_f32 v151, v151
    v_smfmac_f32_32x32x32_bf16 v[64:79], v[192:195], v[128:135], v7
    s_waitcnt lgkmcnt(0)
    ds_read_b64_tr_b16 v[200:201], v8 offset:49152
    v_exp_f32 v152, v152
    v_exp_f32 v153, v153
    v_exp_f32 v154, v154
    v_exp_f32 v155, v155
    v_smfmac_f32_32x32x32_bf16 v[64:79], v[196:199], v[136:143], v7
    ds_read_b64_tr_b16 v[202:203], v8 offset:49376
    v_exp_f32 v156, v156
    v_exp_f32 v157, v157
    v_exp_f32 v158, v158
    v_exp_f32 v159, v159
    v_mfma_f32_32x32x16_bf16 v[112:127], v[184:187], v[16:19], 0
    v_exp_f32 v160, v160
    v_exp_f32 v161, v161
    v_exp_f32 v162, v162
    v_exp_f32 v163, v163
    v_mfma_f32_32x32x16_bf16 v[112:127], v[188:191], v[20:23], v[112:127]
    v_exp_f32 v164, v164
    v_exp_f32 v165, v165
    v_exp_f32 v166, v166
    v_exp_f32 v167, v167
    v_smfmac_f32_32x32x32_bf16 v[80:95], v[192:195], v[144:151], v7
    ds_read_b64_tr_b16 v[204:205], v9 offset:49152
    v_exp_f32 v168, v168
    v_exp_f32 v169, v169
    v_exp_f32 v170, v170
    v_exp_f32 v171, v171
    v_smfmac_f32_32x32x32_bf16 v[80:95], v[196:199], v[152:159], v7
    ds_read_b64_tr_b16 v[206:207], v9 offset:49376
    v_exp_f32 v172, v172
    v_exp_f32 v173, v173
    v_exp_f32 v174, v174
    v_exp_f32 v175, v175
    v_mfma_f32_32x32x16_bf16 v[128:143], v[184:187], v[24:27], 0
    v_exp_f32 v112, v112
    v_exp_f32 v113, v113
    v_exp_f32 v114, v114
    v_exp_f32 v115, v115
    v_mfma_f32_32x32x16_bf16 v[128:143], v[188:191], v[28:31], v[128:143]
    v_exp_f32 v116, v116
    v_exp_f32 v117, v117
    v_exp_f32 v118, v118
    v_exp_f32 v119, v119
    v_smfmac_f32_32x32x32_bf16 v[96:111], v[192:195], v[160:167], v7
    s_waitcnt vmcnt(0) lgkmcnt(0)
    s_barrier
    v_exp_f32 v120, v120
    v_exp_f32 v121, v121
    v_exp_f32 v122, v122
    v_exp_f32 v123, v123
    v_smfmac_f32_32x32x32_bf16 v[96:111], v[196:199], v[168:175], v7
    ds_read_b128 v[176:179], v250 offset:0
    v_exp_f32 v124, v124
    v_exp_f32 v125, v125
    v_exp_f32 v126, v126
    v_exp_f32 v127, v127
    v_mfma_f32_32x32x16_bf16 v[144:159], v[184:187], v[32:35], 0
    v_exp_f32 v128, v128
    v_exp_f32 v129, v129
    v_exp_f32 v130, v130
    v_exp_f32 v131, v131
    v_mfma_f32_32x32x16_bf16 v[144:159], v[188:191], v[36:39], v[144:159]
    s_cbranch_vccnz L_prio_12
    s_setprio 1
L_prio_12:
    v_exp_f32 v132, v132
    v_exp_f32 v133, v133
    v_exp_f32 v134, v134
    v_exp_f32 v135, v135
    v_smfmac_f32_32x32x32_bf16 v[48:63], v[200:203], v[112:119], v7
    v_exp_f32 v136, v136
    v_exp_f32 v137, v137
    v_exp_f32 v138, v138
    v_exp_f32 v139, v139
    v_smfmac_f32_32x32x32_bf16 v[48:63], v[204:207], v[120:127], v7
    ds_read_b128 v[180:183], v250 offset:1024
    v_exp_f32 v140, v140
    v_exp_f32 v141, v141
    v_exp_f32 v142, v142
    v_exp_f32 v143, v143
    v_mfma_f32_32x32x16_bf16 v[160:175], v[184:187], v[40:43], 0
    v_exp_f32 v144, v144
    v_exp_f32 v145, v145
    v_exp_f32 v146, v146
    v_exp_f32 v147, v147
    v_mfma_f32_32x32x16_bf16 v[160:175], v[188:191], v[44:47], v[160:175]
    v_exp_f32 v148, v148
    v_exp_f32 v149, v149
    v_exp_f32 v150, v150
    v_exp_f32 v151, v151
    v_smfmac_f32_32x32x32_bf16 v[64:79], v[200:203], v[128:135], v7
    s_waitcnt lgkmcnt(0)
    ds_read_b64_tr_b16 v[192:193], v251 offset:0
    v_exp_f32 v152, v152
    v_exp_f32 v153, v153
    v_exp_f32 v154, v154
    v_exp_f32 v155, v155
    v_smfmac_f32_32x32x32_bf16 v[64:79], v[204:207], v[136:143], v7
    ds_read_b64_tr_b16 v[194:195], v251 offset:224
    v_exp_f32 v156, v156
    v_exp_f32 v157, v157
    v_exp_f32 v158, v158
    v_exp_f32 v159, v159
    v_mfma_f32_32x32x16_bf16 v[112:127], v[176:179], v[16:19], 0
    v_exp_f32 v160, v160
    v_exp_f32 v161, v161
    v_exp_f32 v162, v162
    v_exp_f32 v163, v163
    v_mfma_f32_32x32x16_bf16 v[112:127], v[180:183], v[20:23], v[112:127]
    v_exp_f32 v164, v164
    v_exp_f32 v165, v165
    v_exp_f32 v166, v166
    v_exp_f32 v167, v167
    v_smfmac_f32_32x32x32_bf16 v[80:95], v[200:203], v[144:151], v7
    ds_read_b64_tr_b16 v[196:197], v252 offset:0
    v_exp_f32 v168, v168
    v_exp_f32 v169, v169
    v_exp_f32 v170, v170
    v_exp_f32 v171, v171
    v_smfmac_f32_32x32x32_bf16 v[80:95], v[204:207], v[152:159], v7
    s_sub_u32 s54, s54, 1
    s_cmp_lg_u32 s54, 0
    ds_read_b64_tr_b16 v[198:199], v252 offset:224
    v_exp_f32 v172, v172
    v_exp_f32 v173, v173
    v_exp_f32 v174, v174
    v_exp_f32 v175, v175
    s_cbranch_scc1 L_loop
    v_mfma_f32_32x32x16_bf16 v[128:143], v[176:179], v[24:27], 0
    s_lshl_b32 s68, s48, 2
    v_exp_f32 v112, v112
    v_exp_f32 v113, v113
    v_exp_f32 v114, v114
    v_exp_f32 v115, v115
    v_mfma_f32_32x32x16_bf16 v[128:143], v[180:183], v[28:31], v[128:143]
    s_add_u32 s64, s47, 1
    v_exp_f32 v116, v116
    v_exp_f32 v117, v117
    v_exp_f32 v118, v118
    v_exp_f32 v119, v119
    v_smfmac_f32_32x32x32_bf16 v[96:111], v[200:203], v[160:167], v7
    s_and_b32 s64, s64, 3
    s_add_u32 s64, s64, s68
    v_exp_f32 v120, v120
    v_exp_f32 v121, v121
    v_exp_f32 v122, v122
    v_exp_f32 v123, v123
    v_smfmac_f32_32x32x32_bf16 v[96:111], v[204:207], v[168:175], v7
    s_mul_i32 s64, s64, 12288
    s_add_u32 s64, s64, 65536
    ds_read_b128 v[184:187], v250 offset:16384
    v_exp_f32 v124, v124
    v_exp_f32 v125, v125
    v_exp_f32 v126, v126
    v_exp_f32 v127, v127
    v_add_u32 v10, s64, v3
    v_mfma_f32_32x32x16_bf16 v[144:159], v[176:179], v[32:35], 0
    v_exp_f32 v128, v128
    v_exp_f32 v129, v129
    v_exp_f32 v130, v130
    v_exp_f32 v131, v131
    v_mfma_f32_32x32x16_bf16 v[144:159], v[180:183], v[36:39], v[144:159]
    s_waitcnt lgkmcnt(1)
    s_add_u32 s64, s47, 2
    v_exp_f32 v132, v132
    v_exp_f32 v133, v133
    v_exp_f32 v134, v134
    v_exp_f32 v135, v135
    v_smfmac_f32_32x32x32_bf16 v[48:63], v[192:195], v[112:119], v7
    s_and_b32 s64, s64, 3
    s_add_u32 s64, s64, s68
    v_exp_f32 v136, v136
    v_exp_f32 v137, v137
    v_exp_f32 v138, v138
    v_exp_f32 v139, v139
    v_smfmac_f32_32x32x32_bf16 v[48:63], v[196:199], v[120:127], v7
    s_mul_i32 s64, s64, 12288
    s_add_u32 s64, s64, 69632
    ds_read_b128 v[188:191], v250 offset:17408
    v_exp_f32 v140, v140
    v_exp_f32 v141, v141
    v_exp_f32 v142, v142
    v_exp_f32 v143, v143
    v_add_u32 v11, s64, v3
    v_mfma_f32_32x32x16_bf16 v[160:175], v[176:179], v[40:43], 0
    v_exp_f32 v144, v144
    v_exp_f32 v145, v145
    v_exp_f32 v146, v146
    v_exp_f32 v147, v147
    v_mfma_f32_32x32x16_bf16 v[160:175], v[180:183], v[44:47], v[160:175]
    s_add_u32 s64, s47, 3
    v_exp_f32 v148, v148
    v_exp_f32 v149, v149
    v_exp_f32 v150, v150
    v_exp_f32 v151, v151
    v_smfmac_f32_32x32x32_bf16 v[64:79], v[192:195], v[128:135], v7
    s_waitcnt lgkmcnt(0)
    ds_read_b64_tr_b16 v[200:201], v251 offset:16384
    s_and_b32 s64, s64, 3
    s_add_u32 s64, s64, s68
    v_exp_f32 v152, v152
    v_exp_f32 v153, v153
    v_exp_f32 v154, v154
    v_exp_f32 v155, v155
    v_smfmac_f32_32x32x32_bf16 v[64:79], v[196:199], v[136:143], v7
    s_mul_i32 s64, s64, 12288
    s_add_u32 s64, s64, 73728
    ds_read_b64_tr_b16 v[202:203], v251 offset:16608
    v_exp_f32 v156, v156
    v_exp_f32 v157, v157
    v_exp_f32 v158, v158
    v_exp_f32 v159, v159
    v_add_u32 v12, s64, v3
    v_mfma_f32_32x32x16_bf16 v[112:127], v[184:187], v[16:19], 0
    v_exp_f32 v160, v160
    v_exp_f32 v161, v161
    v_exp_f32 v162, v162
    v_exp_f32 v163, v163
    v_mfma_f32_32x32x16_bf16 v[112:127], v[188:191], v[20:23], v[112:127]
    s_add_u32 s64, s47, 4
    v_exp_f32 v164, v164
    v_exp_f32 v165, v165
    v_exp_f32 v166, v166
    v_exp_f32 v167, v167
    v_smfmac_f32_32x32x32_bf16 v[80:95], v[192:195], v[144:151], v7
    ds_read_b64_tr_b16 v[204:205], v252 offset:16384
    s_and_b32 s64, s64, 3
    s_add_u32 s64, s64, s68
    v_exp_f32 v168, v168
    v_exp_f32 v169, v169
    v_exp_f32 v170, v170
    v_exp_f32 v171, v171
    v_smfmac_f32_32x32x32_bf16 v[80:95], v[196:199], v[152:159], v7
    s_mul_i32 s64, s64, 12288
    s_add_u32 s64, s64, 65536
    ds_read_b64_tr_b16 v[206:207], v252 offset:16608
    v_exp_f32 v172, v172
    v_exp_f32 v173, v173
    v_exp_f32 v174, v174
    v_exp_f32 v175, v175
    v_add_u32 v13, s64, v3
    v_mfma_f32_32x32x16_bf16 v[128:143], v[184:187], v[24:27], 0
    v_exp_f32 v112, v112
    v_exp_f32 v113, v113
    v_exp_f32 v114, v114
    v_exp_f32 v115, v115
    v_mfma_f32_32x32x16_bf16 v[128:143], v[188:191], v[28:31], v[128:143]
    v_exp_f32 v116, v116
    v_exp_f32 v117, v117
    v_exp_f32 v118, v118
    v_exp_f32 v119, v119
    v_smfmac_f32_32x32x32_bf16 v[96:111], v[192:195], v[160:167], v7
    v_exp_f32 v120, v120
    v_exp_f32 v121, v121
    v_exp_f32 v122, v122
    v_exp_f32 v123, v123
    v_smfmac_f32_32x32x32_bf16 v[96:111], v[196:199], v[168:175], v7
    v_exp_f32 v124, v124
    v_exp_f32 v125, v125
    v_exp_f32 v126, v126
    v_exp_f32 v127, v127
    v_mov_b32 v1, 3852
    v_mfma_f32_32x32x16_bf16 v[144:159], v[184:187], v[32:35], 0
    v_exp_f32 v128, v128
    v_exp_f32 v129, v129
    v_exp_f32 v130, v130
    v_exp_f32 v131, v131
    v_mfma_f32_32x32x16_bf16 v[144:159], v[188:191], v[36:39], v[144:159]
    s_waitcnt lgkmcnt(0)
    v_exp_f32 v132, v132
    v_exp_f32 v133, v133
    v_exp_f32 v134, v134
    v_exp_f32 v135, v135
    v_smfmac_f32_32x32x32_bf16 v[48:63], v[200:203], v[112:119], v7
    v_exp_f32 v136, v136
    v_exp_f32 v137, v137
    v_exp_f32 v138, v138
    v_exp_f32 v139, v139
    v_smfmac_f32_32x32x32_bf16 v[48:63], v[204:207], v[120:127], v7
    v_exp_f32 v140, v140
    v_exp_f32 v141, v141
    v_exp_f32 v142, v142
    v_exp_f32 v143, v143
    v_mfma_f32_32x32x16_bf16 v[160:175], v[184:187], v[40:43], 0
    ds_read_b128 v[176:179], v242 offset:32768
    v_exp_f32 v144, v144
    v_exp_f32 v145, v145
    v_exp_f32 v146, v146
    v_exp_f32 v147, v147
    v_mfma_f32_32x32x16_bf16 v[160:175], v[188:191], v[44:47], v[160:175]
    ds_read_b128 v[180:183], v242 offset:33792
    v_exp_f32 v148, v148
    v_exp_f32 v149, v149
    v_exp_f32 v150, v150
    v_exp_f32 v151, v151
    v_smfmac_f32_32x32x32_bf16 v[64:79], v[200:203], v[128:135], v7
    ds_write_b128 v10, v[48:51] offset:0
    v_exp_f32 v152, v152
    v_exp_f32 v153, v153
    v_exp_f32 v154, v154
    v_exp_f32 v155, v155
    v_smfmac_f32_32x32x32_bf16 v[64:79], v[204:207], v[136:143], v7
    s_waitcnt lgkmcnt(1)
    ds_write_b128 v10, v[52:55] offset:1024
    v_exp_f32 v156, v156
    v_exp_f32 v157, v157
    v_exp_f32 v158, v158
    v_exp_f32 v159, v159
    v_mfma_f32_32x32x16_bf16 v[112:127], v[176:179], v[40:43], 0
    ds_read_b64_tr_b16 v[192:193], v243 offset:32768
    ds_read_b64_tr_b16 v[194:195], v243 offset:32992
    ds_read_b128 v[184:187], v242 offset:36864
    v_exp_f32 v160, v160
    v_exp_f32 v161, v161
    v_exp_f32 v162, v162
    v_exp_f32 v163, v163
    v_mfma_f32_32x32x16_bf16 v[112:127], v[180:183], v[44:47], v[112:127]
    ds_read_b64_tr_b16 v[196:197], v244 offset:32768
    ds_read_b64_tr_b16 v[198:199], v244 offset:32992
    ds_read_b128 v[188:191], v242 offset:37888
    v_exp_f32 v164, v164
    v_exp_f32 v165, v165
    v_exp_f32 v166, v166
    v_exp_f32 v167, v167
    v_smfmac_f32_32x32x32_bf16 v[80:95], v[200:203], v[144:151], v7
    ds_write_b128 v10, v[56:59] offset:2048
    v_exp_f32 v168, v168
    v_exp_f32 v169, v169
    v_exp_f32 v170, v170
    v_exp_f32 v171, v171
    v_smfmac_f32_32x32x32_bf16 v[80:95], v[204:207], v[152:159], v7
    s_waitcnt lgkmcnt(1)
    ds_write_b128 v10, v[60:63] offset:3072
    v_exp_f32 v172, v172
    v_exp_f32 v173, v173
    v_exp_f32 v174, v174
    v_exp_f32 v175, v175
    v_mfma_f32_32x32x16_bf16 v[128:143], v[184:187], v[40:43], 0
    ds_read_b128 v[176:179], v242 offset:40960
    v_exp_f32 v112, v112
    v_exp_f32 v113, v113
    v_exp_f32 v114, v114
    v_exp_f32 v115, v115
    v_mfma_f32_32x32x16_bf16 v[128:143], v[188:191], v[44:47], v[128:143]
    ds_read_b128 v[180:183], v242 offset:41984
    v_exp_f32 v116, v116
    v_exp_f32 v117, v117
    v_exp_f32 v118, v118
    v_exp_f32 v119, v119
    v_smfmac_f32_32x32x32_bf16 v[96:111], v[200:203], v[160:167], v7
    ds_write_b128 v11, v[64:67] offset:0
    v_exp_f32 v120, v120
    v_exp_f32 v121, v121
    v_exp_f32 v122, v122
    v_exp_f32 v123, v123
    v_smfmac_f32_32x32x32_bf16 v[96:111], v[204:207], v[168:175], v7
    s_waitcnt lgkmcnt(1)
    ds_write_b128 v11, v[68:71] offset:1024
    v_exp_f32 v124, v124
    v_exp_f32 v125, v125
    v_exp_f32 v126, v126
    v_exp_f32 v127, v127
    v_mfma_f32_32x32x16_bf16 v[144:159], v[176:179], v[40:43], 0
    ds_read_b64_tr_b16 v[200:201], v243 offset:36864
    ds_read_b64_tr_b16 v[202:203], v243 offset:37088
    ds_read_b128 v[184:187], v242 offset:45056
    v_exp_f32 v128, v128
    v_exp_f32 v129, v129
    v_exp_f32 v130, v130
    v_exp_f32 v131, v131
    v_mfma_f32_32x32x16_bf16 v[144:159], v[180:183], v[44:47], v[144:159]
    ds_read_b64_tr_b16 v[204:205], v244 offset:36864
    ds_read_b64_tr_b16 v[206:207], v244 offset:37088
    ds_read_b128 v[188:191], v242 offset:46080
    v_exp_f32 v132, v132
    v_exp_f32 v133, v133
    v_exp_f32 v134, v134
    v_exp_f32 v135, v135
    v_smfmac_f32_32x32x32_bf16 v[96:111], v[192:195], v[112:119], v7
    ds_write_b128 v11, v[72:75] offset:2048
    v_exp_f32 v136, v136
    v_exp_f32 v137, v137
    v_exp_f32 v138, v138
    v_exp_f32 v139, v139
    v_smfmac_f32_32x32x32_bf16 v[96:111], v[196:199], v[120:127], v7
    s_waitcnt lgkmcnt(1)
    ds_write_b128 v11, v[76:79] offset:3072
    v_exp_f32 v140, v140
    v_exp_f32 v141, v141
    v_exp_f32 v142, v142
    v_exp_f32 v143, v143
    v_mfma_f32_32x32x16_bf16 v[160:175], v[184:187], v[40:43], 0
    ds_read_b64_tr_b16 v[192:193], v243 offset:40960
    ds_read_b64_tr_b16 v[194:195], v243 offset:41184
    ds_read_b128 v[176:179], v242 offset:49152
    v_exp_f32 v144, v144
    v_exp_f32 v145, v145
    v_exp_f32 v146, v146
    v_exp_f32 v147, v147
    v_mfma_f32_32x32x16_bf16 v[160:175], v[188:191], v[44:47], v[160:175]
    ds_read_b64_tr_b16 v[196:197], v244 offset:40960
    ds_read_b64_tr_b16 v[198:199], v244 offset:41184
    ds_read_b128 v[180:183], v242 offset:50176
    v_exp_f32 v148, v148
    v_exp_f32 v149, v149
    v_exp_f32 v150, v150
    v_exp_f32 v151, v151
    v_smfmac_f32_32x32x32_bf16 v[96:111], v[200:203], v[128:135], v7
    ds_write_b128 v12, v[80:83] offset:0
    v_exp_f32 v152, v152
    v_exp_f32 v153, v153
    v_exp_f32 v154, v154
    v_exp_f32 v155, v155
    v_smfmac_f32_32x32x32_bf16 v[96:111], v[204:207], v[136:143], v7
    s_waitcnt lgkmcnt(1)
    ds_write_b128 v12, v[84:87] offset:1024
    v_exp_f32 v156, v156
    v_exp_f32 v157, v157
    v_exp_f32 v158, v158
    v_exp_f32 v159, v159
    v_mfma_f32_32x32x16_bf16 v[112:127], v[176:179], v[40:43], 0
    ds_read_b64_tr_b16 v[200:201], v243 offset:45056
    ds_read_b64_tr_b16 v[202:203], v243 offset:45280
    ds_read_b128 v[184:187], v242 offset:53248
    v_exp_f32 v160, v160
    v_exp_f32 v161, v161
    v_exp_f32 v162, v162
    v_exp_f32 v163, v163
    v_mfma_f32_32x32x16_bf16 v[112:127], v[180:183], v[44:47], v[112:127]
    s_cbranch_vccnz L_prio_13
    s_setprio 0
L_prio_13:
    ds_read_b64_tr_b16 v[204:205], v244 offset:45056
    ds_read_b64_tr_b16 v[206:207], v244 offset:45280
    ds_read_b128 v[188:191], v242 offset:54272
    v_exp_f32 v164, v164
    v_exp_f32 v165, v165
    v_exp_f32 v166, v166
    v_exp_f32 v167, v167
    v_smfmac_f32_32x32x32_bf16 v[96:111], v[192:195], v[144:151], v7
    ds_write_b128 v12, v[88:91] offset:2048
    v_exp_f32 v168, v168
    v_exp_f32 v169, v169
    v_exp_f32 v170, v170
    v_exp_f32 v171, v171
    v_smfmac_f32_32x32x32_bf16 v[96:111], v[196:199], v[152:159], v7
    s_waitcnt lgkmcnt(1)
    ds_write_b128 v12, v[92:95] offset:3072
    v_exp_f32 v172, v172
    v_exp_f32 v173, v173
    v_exp_f32 v174, v174
    v_exp_f32 v175, v175
    v_mfma_f32_32x32x16_bf16 v[128:143], v[184:187], v[40:43], 0
    ds_read_b64_tr_b16 v[192:193], v243 offset:49152
    ds_read_b64_tr_b16 v[194:195], v243 offset:49376
    ds_read_b128 v[176:179], v242 offset:57344
    v_exp_f32 v112, v112
    v_exp_f32 v113, v113
    v_exp_f32 v114, v114
    v_exp_f32 v115, v115
    v_mfma_f32_32x32x16_bf16 v[128:143], v[188:191], v[44:47], v[128:143]
    ds_read_b64_tr_b16 v[196:197], v244 offset:49152
    ds_read_b64_tr_b16 v[198:199], v244 offset:49376
    ds_read_b128 v[180:183], v242 offset:58368
    v_exp_f32 v116, v116
    v_exp_f32 v117, v117
    v_exp_f32 v118, v118
    v_exp_f32 v119, v119
    v_smfmac_f32_32x32x32_bf16 v[96:111], v[200:203], v[160:167], v7
    v_exp_f32 v120, v120
    v_exp_f32 v121, v121
    v_exp_f32 v122, v122
    v_exp_f32 v123, v123
    v_smfmac_f32_32x32x32_bf16 v[96:111], v[204:207], v[168:175], v7
    s_waitcnt lgkmcnt(0)
    v_exp_f32 v124, v124
    v_exp_f32 v125, v125
    v_exp_f32 v126, v126
    v_exp_f32 v127, v127
    v_mfma_f32_32x32x16_bf16 v[144:159], v[176:179], v[40:43], 0
    ds_read_b64_tr_b16 v[200:201], v243 offset:53248
    ds_read_b64_tr_b16 v[202:203], v243 offset:53472
    ds_read_b128 v[184:187], v242 offset:61440
    v_exp_f32 v128, v128
    v_exp_f32 v129, v129
    v_exp_f32 v130, v130
    v_exp_f32 v131, v131
    v_mfma_f32_32x32x16_bf16 v[144:159], v[180:183], v[44:47], v[144:159]
    ds_read_b64_tr_b16 v[204:205], v244 offset:53248
    ds_read_b64_tr_b16 v[206:207], v244 offset:53472
    ds_read_b128 v[188:191], v242 offset:62464
    v_exp_f32 v132, v132
    v_exp_f32 v133, v133
    v_exp_f32 v134, v134
    v_exp_f32 v135, v135
    v_smfmac_f32_32x32x32_bf16 v[96:111], v[192:195], v[112:119], v7
    v_exp_f32 v136, v136
    v_exp_f32 v137, v137
    v_exp_f32 v138, v138
    v_exp_f32 v139, v139
    v_smfmac_f32_32x32x32_bf16 v[96:111], v[196:199], v[120:127], v7
    s_waitcnt lgkmcnt(0)
    v_exp_f32 v140, v140
    v_exp_f32 v141, v141
    v_exp_f32 v142, v142
    v_exp_f32 v143, v143
    v_mfma_f32_32x32x16_bf16 v[160:175], v[184:187], v[40:43], 0
    ds_read_b64_tr_b16 v[192:193], v243 offset:57344
    ds_read_b64_tr_b16 v[194:195], v243 offset:57568
    v_exp_f32 v144, v144
    v_exp_f32 v145, v145
    v_exp_f32 v146, v146
    v_exp_f32 v147, v147
    v_mfma_f32_32x32x16_bf16 v[160:175], v[188:191], v[44:47], v[160:175]
    ds_read_b64_tr_b16 v[196:197], v244 offset:57344
    ds_read_b64_tr_b16 v[198:199], v244 offset:57568
    v_exp_f32 v148, v148
    v_exp_f32 v149, v149
    v_exp_f32 v150, v150
    v_exp_f32 v151, v151
    v_smfmac_f32_32x32x32_bf16 v[96:111], v[200:203], v[128:135], v7
    s_cmp_eq_u32 s59, 0
    s_cbranch_scc1 L_noabort
    ds_write_b32 v1, v7
L_noabort:
    s_waitcnt lgkmcnt(0)
    s_barrier
    ds_read_b32 v6, v1
    ds_read_b128 v[48:51], v13 offset:0
    ds_read_b128 v[52:55], v13 offset:1024
    ds_read_b128 v[56:59], v13 offset:2048
    ds_read_b128 v[60:63], v13 offset:3072
    ds_read_b128 v[64:67], v13 offset:4096
    ds_read_b128 v[68:71], v13 offset:5120
    ds_read_b128 v[72:75], v13 offset:6144
    ds_read_b128 v[76:79], v13 offset:7168
    v_exp_f32 v152, v152
    v_exp_f32 v153, v153
    v_exp_f32 v154, v154
    v_exp_f32 v155, v155
    v_smfmac_f32_32x32x32_bf16 v[96:111], v[204:207], v[136:143], v7
    v_exp_f32 v156, v156
    v_exp_f32 v157, v157
    v_exp_f32 v158, v158
    v_exp_f32 v159, v159
    v_smfmac_f32_32x32x32_bf16 v[96:111], v[192:195], v[144:151], v7
    ds_read_b64_tr_b16 v[200:201], v243 offset:61440
    ds_read_b64_tr_b16 v[202:203], v243 offset:61664
    v_exp_f32 v160, v160
    v_exp_f32 v161, v161
    v_exp_f32 v162, v162
    v_exp_f32 v163, v163
    v_smfmac_f32_32x32x32_bf16 v[96:111], v[196:199], v[152:159], v7
    ds_read_b64_tr_b16 v[204:205], v244 offset:61440
    ds_read_b64_tr_b16 v[206:207], v244 offset:61664
    v_exp_f32 v164, v164
    v_exp_f32 v165, v165
    v_exp_f32 v166, v166
    v_exp_f32 v167, v167
    s_waitcnt lgkmcnt(8)
    ds_read_b128 v[80:83], v13 offset:8192
    ds_read_b128 v[84:87], v13 offset:9216
    ds_read_b128 v[88:91], v13 offset:10240
    ds_read_b128 v[92:95], v13 offset:11264
    v_exp_f32 v168, v168
    v_exp_f32 v169, v169
    v_exp_f32 v170, v170
    v_exp_f32 v171, v171
    v_exp_f32 v172, v172
    v_exp_f32 v173, v173
    v_exp_f32 v174, v174
    v_exp_f32 v175, v175
    s_waitcnt lgkmcnt(4)
    v_smfmac_f32_32x32x32_bf16 v[96:111], v[200:203], v[160:167], v7
    v_readfirstlane_b32 s64, v6
    v_smfmac_f32_32x32x32_bf16 v[96:111], v[204:207], v[168:175], v7
    s_cmp_lg_u32 s64, 0
    s_cbranch_scc1 L_slow
    v_pk_add_f32 v[48:49], v[48:49], v[64:65]
    v_pk_add_f32 v[50:51], v[50:51], v[66:67]
    v_pk_add_f32 v[52:53], v[52:53], v[68:69]
    v_pk_add_f32 v[54:55], v[54:55], v[70:71]
    v_pk_add_f32 v[56:57], v[56:57], v[72:73]
    v_pk_add_f32 v[58:59], v[58:59], v[74:75]
    v_pk_add_f32 v[60:61], v[60:61], v[76:77]
    v_pk_add_f32 v[62:63], v[62:63], v[78:79]
    v_mov_b32 v8, v13
    v_sub_u32 v4, v13, v3
    v_add_u32 v4, v4, v5
    s_waitcnt lgkmcnt(0)
    v_pk_add_f32 v[48:49], v[48:49], v[80:81]
    v_pk_add_f32 v[50:51], v[50:51], v[82:83]
    v_pk_add_f32 v[52:53], v[52:53], v[84:85]
    v_pk_add_f32 v[54:55], v[54:55], v[86:87]
    v_pk_add_f32 v[56:57], v[56:57], v[88:89]
    v_pk_add_f32 v[58:59], v[58:59], v[90:91]
    v_pk_add_f32 v[60:61], v[60:61], v[92:93]
    v_pk_add_f32 v[62:63], v[62:63], v[94:95]
    v_pk_add_f32 v[108:109], v[108:109], v[60:61]
    v_mov_b32 v14, v108
    v_mov_b32 v15, v108
    v_pk_add_f32 v[96:97], v[96:97], v[48:49]
    v_pk_add_f32 v[98:99], v[98:99], v[50:51]
    v_permlane32_swap_b32 v14, v15
    v_pk_add_f32 v[100:101], v[100:101], v[52:53]
    v_rcp_f32 v15, v15
    v_pk_add_f32 v[102:103], v[102:103], v[54:55]
    v_pk_mul_f32 v[96:97], v[96:97], v[14:15] op_sel:[0,1] op_sel_hi:[1,1]
    v_cvt_pk_bf16_f32 v96, v96, v97
    v_pk_mul_f32 v[98:99], v[98:99], v[14:15] op_sel:[0,1] op_sel_hi:[1,1]
    v_cvt_pk_bf16_f32 v97, v98, v99
    ds_write_b64 v4, v[96:97] offset:0
    v_pk_mul_f32 v[100:101], v[100:101], v[14:15] op_sel:[0,1] op_sel_hi:[1,1]
    v_cvt_pk_bf16_f32 v98, v100, v101
    v_pk_mul_f32 v[102:103], v[102:103], v[14:15] op_sel:[0,1] op_sel_hi:[1,1]
    v_cvt_pk_bf16_f32 v99, v102, v103
    ds_write_b64 v4, v[98:99] offset:8
    v_pk_add_f32 v[104:105], v[104:105], v[56:57]
    v_pk_mul_f32 v[104:105], v[104:105], v[14:15] op_sel:[0,1] op_sel_hi:[1,1]
    v_cvt_pk_bf16_f32 v100, v104, v105
    v_pk_add_f32 v[106:107], v[106:107], v[58:59]
    v_pk_mul_f32 v[106:107], v[106:107], v[14:15] op_sel:[0,1] op_sel_hi:[1,1]
    v_cvt_pk_bf16_f32 v101, v106, v107
    ds_write_b64 v4, v[100:101] offset:16
    v_pk_mul_f32 v[108:109], v[108:109], v[14:15] op_sel:[0,1] op_sel_hi:[1,1]
    v_cvt_pk_bf16_f32 v102, v108, v109
    v_pk_add_f32 v[110:111], v[110:111], v[62:63]
    v_pk_mul_f32 v[110:111], v[110:111], v[14:15] op_sel:[0,1] op_sel_hi:[1,1]
    v_cvt_pk_bf16_f32 v103, v110, v111
    s_mov_b32 exec_hi, 0
    ds_write_b64 v4, v[102:103] offset:24
    s_mov_b32 exec_hi, -1
    ds_read_b128 v[104:107], v8
    ds_read_b128 v[108:111], v8 offset:1024
    s_waitcnt lgkmcnt(1)
    buffer_store_dwordx4 v[104:107], v3, s[32:35], s60 offen sc1
    s_mov_b64 exec, s[62:63]
    s_waitcnt lgkmcnt(0)
    buffer_store_dwordx4 v[108:111], v3, s[32:35], s60 offen offset:1024 sc1
    s_mov_b64 exec, -1
L_end:
    s_endpgm
L_slow0:
    s_add_u32 s32, s12, s64
    s_addc_u32 s33, s13, 0
L_slow:
    s_setprio 0
    s_waitcnt vmcnt(0) lgkmcnt(0)
    s_barrier
    buffer_load_dwordx4 v[128:131], v2, s[20:23], s60 offen
    buffer_load_dwordx3 v[132:134], v2, s[20:23], s60 offen offset:16
    s_lshl_b32 s52, s46, 12
    v_add_u32 v10, s52, v3
    v_mov_b32 v176, 0x3f80
    v_mov_b32 v177, 0
    v_mov_b32 v178, 0x3f80
    v_mov_b32 v179, 0
    s_mov_b64 exec, 0xffff
    ds_write_b128 v10, v[176:179] offset:3840
    s_mov_b64 exec, -1
    v_mov_b32 v135, 0
    v_mov_b32 v160, 0xff800000
    s_nop 7
    v_mov_b32 v48, 0
    v_mov_b32 v49, 0
    v_mov_b32 v50, 0
    v_mov_b32 v51, 0
    v_mov_b32 v52, 0
    v_mov_b32 v53, 0
    v_mov_b32 v54, 0
    v_mov_b32 v55, 0
    v_mov_b32 v56, 0
    v_mov_b32 v57, 0
    v_mov_b32 v58, 0
    v_mov_b32 v59, 0
    v_mov_b32 v60, 0
    v_mov_b32 v61, 0
    v_mov_b32 v62, 0
    v_mov_b32 v63, 0
    s_waitcnt vmcnt(0)
    v_dot2_f32_bf16 v164, v128, v128, 0
    v_dot2_f32_bf16 v165, v129, v129, 0
    v_dot2_f32_bf16 v164, v130, v130, v164
    v_dot2_f32_bf16 v165, v131, v131, v165
    v_dot2_f32_bf16 v164, v132, v132, v164
    v_dot2_f32_bf16 v165, v133, v133, v165
    v_dot2_f32_bf16 v164, v134, v134, v164
    s_nop 2
    v_add_f32 v164, v164, v165
    v_lshlrev_b32 v152, 16, v128
    v_and_b32 v153, 0xffff0000, v128
    v_add_f32_dpp v164, v164, v164 quad_perm:[1,0,3,2] row_mask:0xf bank_mask:0xf
    v_sqrt_f32 v164, v164
    v_lshlrev_b32 v154, 16, v129
    v_add_f32 v164, 0x358637bd, v164
    v_rcp_f32 v164, v164
    v_and_b32 v155, 0xffff0000, v129
    v_mul_f32 v164, s58, v164
    v_lshlrev_b32 v156, 16, v130
    v_and_b32 v157, 0xffff0000, v130
    v_pk_mul_f32 v[152:153], v[152:153], v[164:165] op_sel_hi:[1,0]
    v_cvt_pk_bf16_f32 v128, v152, v153
    v_lshlrev_b32 v152, 16, v131
    v_and_b32 v153, 0xffff0000, v131
    v_pk_mul_f32 v[154:155], v[154:155], v[164:165] op_sel_hi:[1,0]
    v_cvt_pk_bf16_f32 v129, v154, v155
    v_lshlrev_b32 v154, 16, v132
    v_and_b32 v155, 0xffff0000, v132
    v_pk_mul_f32 v[156:157], v[156:157], v[164:165] op_sel_hi:[1,0]
    v_cvt_pk_bf16_f32 v130, v156, v157
    v_lshlrev_b32 v156, 16, v133
    v_and_b32 v157, 0xffff0000, v133
    v_pk_mul_f32 v[152:153], v[152:153], v[164:165] op_sel_hi:[1,0]
    v_cvt_pk_bf16_f32 v131, v152, v153
    v_lshlrev_b32 v152, 16, v134
    v_and_b32 v153, 0xffff0000, v134
    v_pk_mul_f32 v[154:155], v[154:155], v[164:165] op_sel_hi:[1,0]
    v_cvt_pk_bf16_f32 v132, v154, v155
    v_pk_mul_f32 v[156:157], v[156:157], v[164:165] op_sel_hi:[1,0]
    v_cvt_pk_bf16_f32 v133, v156, v157
    v_pk_mul_f32 v[152:153], v[152:153], v[164:165] op_sel_hi:[1,0]
    v_cvt_pk_bf16_f32 v134, v152, v153
    ds_write_b128 v241, v[128:131] offset:0
    ds_write_b128 v241, v[132:135] offset:1024
    ds_read_b128 v[16:19], v10
    ds_read_b128 v[20:23], v10 offset:1024
    s_waitcnt lgkmcnt(0)
    s_mov_b32 s51, s56
    s_mov_b32 s54, 16
L_slow_group:
    buffer_load_dwordx4 v[128:131], v2, s[24:27], s51 offen
    buffer_load_dwordx3 v[132:134], v2, s[24:27], s51 offen offset:16
    s_add_u32 m0, s52, 2048
    s_nop 0
    buffer_load_dwordx4 v3, s[28:31], s51 offen offset:0 lds
    s_mov_b64 exec, s[62:63]
    buffer_load_dwordx4 v3, s[28:31], s51 offen offset:1024 lds
    s_mov_b64 exec, -1
    s_waitcnt vmcnt(0)
    v_dot2_f32_bf16 v164, v128, v128, 0
    v_dot2_f32_bf16 v165, v129, v129, 0
    v_dot2_f32_bf16 v164, v130, v130, v164
    v_dot2_f32_bf16 v165, v131, v131, v165
    v_dot2_f32_bf16 v164, v132, v132, v164
    v_dot2_f32_bf16 v165, v133, v133, v165
    v_dot2_f32_bf16 v164, v134, v134, v164
    s_nop 2
    v_add_f32 v164, v164, v165
    v_lshlrev_b32 v152, 16, v128
    v_and_b32 v153, 0xffff0000, v128
    v_add_f32_dpp v164, v164, v164 quad_perm:[1,0,3,2] row_mask:0xf bank_mask:0xf
    v_sqrt_f32 v164, v164
    v_lshlrev_b32 v154, 16, v129
    v_add_f32 v164, 0x358637bd, v164
    v_rcp_f32 v164, v164
    v_and_b32 v155, 0xffff0000, v129
    v_lshlrev_b32 v156, 16, v130
    v_and_b32 v157, 0xffff0000, v130
    v_pk_mul_f32 v[152:153], v[152:153], v[164:165] op_sel_hi:[1,0]
    v_cvt_pk_bf16_f32 v128, v152, v153
    v_lshlrev_b32 v152, 16, v131
    v_and_b32 v153, 0xffff0000, v131
    v_pk_mul_f32 v[154:155], v[154:155], v[164:165] op_sel_hi:[1,0]
    v_cvt_pk_bf16_f32 v129, v154, v155
    v_lshlrev_b32 v154, 16, v132
    v_and_b32 v155, 0xffff0000, v132
    v_pk_mul_f32 v[156:157], v[156:157], v[164:165] op_sel_hi:[1,0]
    v_cvt_pk_bf16_f32 v130, v156, v157
    v_lshlrev_b32 v156, 16, v133
    v_and_b32 v157, 0xffff0000, v133
    v_pk_mul_f32 v[152:153], v[152:153], v[164:165] op_sel_hi:[1,0]
    v_cvt_pk_bf16_f32 v131, v152, v153
    v_lshlrev_b32 v152, 16, v134
    v_and_b32 v153, 0xffff0000, v134
    v_pk_mul_f32 v[154:155], v[154:155], v[164:165] op_sel_hi:[1,0]
    v_cvt_pk_bf16_f32 v132, v154, v155
    v_pk_mul_f32 v[156:157], v[156:157], v[164:165] op_sel_hi:[1,0]
    v_cvt_pk_bf16_f32 v133, v156, v157
    v_pk_mul_f32 v[152:153], v[152:153], v[164:165] op_sel_hi:[1,0]
    v_cvt_pk_bf16_f32 v134, v152, v153
    ds_write_b128 v241, v[128:131] offset:0
    ds_write_b128 v241, v[132:135] offset:1024
    v_mov_b32 v4, v3
    v_mov_b32 v8, v243
    v_mov_b32 v9, v244
    s_mov_b32 s49, 8
    s_waitcnt lgkmcnt(0)
    s_barrier
L_slow_tile:
    ds_read_b128 v[176:179], v4 offset:0
    ds_read_b128 v[180:183], v4 offset:1024
    ds_read_b64_tr_b16 v[192:193], v8 offset:0
    ds_read_b64_tr_b16 v[194:195], v8 offset:224
    ds_read_b64_tr_b16 v[196:197], v9 offset:0
    ds_read_b64_tr_b16 v[198:199], v9 offset:224
    s_waitcnt lgkmcnt(0)
    v_mfma_f32_32x32x16_bf16 v[112:127], v[176:179], v[16:19], 0
    v_mfma_f32_32x32x16_bf16 v[112:127], v[180:183], v[20:23], v[112:127]
    s_nop 15
    v_max3_f32 v161, v112, v113, v160
    v_max3_f32 v161, v114, v115, v161
    v_max3_f32 v161, v116, v117, v161
    v_max3_f32 v161, v118, v119, v161
    v_max3_f32 v161, v120, v121, v161
    v_max3_f32 v161, v122, v123, v161
    v_max3_f32 v161, v124, v125, v161
    v_max3_f32 v161, v126, v127, v161
    v_mov_b32 v162, v161
    s_nop 1
    v_permlane32_swap_b32 v161, v162
    s_nop 1
    v_max_f32 v161, v161, v162
    v_sub_f32 v162, v160, v161
    v_exp_f32 v162, v162
    v_mov_b32 v160, v161
    v_sub_f32 v112, v112, v161
    v_mul_f32 v48, v162, v48
    v_sub_f32 v113, v113, v161
    v_mul_f32 v49, v162, v49
    v_sub_f32 v114, v114, v161
    v_mul_f32 v50, v162, v50
    v_sub_f32 v115, v115, v161
    v_mul_f32 v51, v162, v51
    v_sub_f32 v116, v116, v161
    v_mul_f32 v52, v162, v52
    v_sub_f32 v117, v117, v161
    v_mul_f32 v53, v162, v53
    v_sub_f32 v118, v118, v161
    v_mul_f32 v54, v162, v54
    v_sub_f32 v119, v119, v161
    v_mul_f32 v55, v162, v55
    v_sub_f32 v120, v120, v161
    v_mul_f32 v56, v162, v56
    v_sub_f32 v121, v121, v161
    v_mul_f32 v57, v162, v57
    v_sub_f32 v122, v122, v161
    v_mul_f32 v58, v162, v58
    v_sub_f32 v123, v123, v161
    v_mul_f32 v59, v162, v59
    v_sub_f32 v124, v124, v161
    v_mul_f32 v60, v162, v60
    v_sub_f32 v125, v125, v161
    v_mul_f32 v61, v162, v61
    v_sub_f32 v126, v126, v161
    v_mul_f32 v62, v162, v62
    v_sub_f32 v127, v127, v161
    v_mul_f32 v63, v162, v63
    v_exp_f32 v112, v112
    v_exp_f32 v113, v113
    v_exp_f32 v114, v114
    v_exp_f32 v115, v115
    v_exp_f32 v116, v116
    v_exp_f32 v117, v117
    v_exp_f32 v118, v118
    v_exp_f32 v119, v119
    v_exp_f32 v120, v120
    v_exp_f32 v121, v121
    v_exp_f32 v122, v122
    v_exp_f32 v123, v123
    v_exp_f32 v124, v124
    v_exp_f32 v125, v125
    v_exp_f32 v126, v126
    v_exp_f32 v127, v127
    s_nop 1
    v_smfmac_f32_32x32x32_bf16 v[48:63], v[192:195], v[112:119], v7
    v_smfmac_f32_32x32x32_bf16 v[48:63], v[196:199], v[120:127], v7
    v_add_u32 v4, 4096, v4
    v_add_u32 v8, 4096, v8
    v_add_u32 v9, 4096, v9
    s_nop 15
    s_sub_u32 s49, s49, 1
    s_cmp_lg_u32 s49, 0
    s_cbranch_scc1 L_slow_tile
    s_barrier
    s_add_u32 s51, s51, 14336
    s_sub_u32 s54, s54, 1
    s_cmp_lg_u32 s54, 0
    s_cbranch_scc1 L_slow_group
    v_mov_b32 v8, v10
    v_add_u32 v4, s52, v5
    s_nop 0
    v_mov_b32 v14, v60
    v_mov_b32 v15, v60
    s_nop 0
    s_nop 0
    v_permlane32_swap_b32 v14, v15
    s_nop 0
    v_rcp_f32 v15, v15
    s_nop 0
    v_pk_mul_f32 v[48:49], v[48:49], v[14:15] op_sel:[0,1] op_sel_hi:[1,1]
    v_cvt_pk_bf16_f32 v48, v48, v49
    v_pk_mul_f32 v[50:51], v[50:51], v[14:15] op_sel:[0,1] op_sel_hi:[1,1]
    v_cvt_pk_bf16_f32 v49, v50, v51
    ds_write_b64 v4, v[48:49] offset:0
    v_pk_mul_f32 v[52:53], v[52:53], v[14:15] op_sel:[0,1] op_sel_hi:[1,1]
    v_cvt_pk_bf16_f32 v50, v52, v53
    v_pk_mul_f32 v[54:55], v[54:55], v[14:15] op_sel:[0,1] op_sel_hi:[1,1]
    v_cvt_pk_bf16_f32 v51, v54, v55
    ds_write_b64 v4, v[50:51] offset:8
    v_pk_mul_f32 v[56:57], v[56:57], v[14:15] op_sel:[0,1] op_sel_hi:[1,1]
    v_cvt_pk_bf16_f32 v52, v56, v57
    v_pk_mul_f32 v[58:59], v[58:59], v[14:15] op_sel:[0,1] op_sel_hi:[1,1]
    v_cvt_pk_bf16_f32 v53, v58, v59
    ds_write_b64 v4, v[52:53] offset:16
    v_pk_mul_f32 v[60:61], v[60:61], v[14:15] op_sel:[0,1] op_sel_hi:[1,1]
    v_cvt_pk_bf16_f32 v54, v60, v61
    v_pk_mul_f32 v[62:63], v[62:63], v[14:15] op_sel:[0,1] op_sel_hi:[1,1]
    v_cvt_pk_bf16_f32 v55, v62, v63
    s_mov_b32 exec_hi, 0
    ds_write_b64 v4, v[54:55] offset:24
    s_mov_b32 exec_hi, -1
    ds_read_b128 v[56:59], v8
    ds_read_b128 v[60:63], v8 offset:1024
    s_waitcnt lgkmcnt(1)
    buffer_store_dwordx4 v[56:59], v3, s[32:35], s60 offen sc1
    s_mov_b64 exec, s[62:63]
    s_waitcnt lgkmcnt(0)
    buffer_store_dwordx4 v[60:63], v3, s[32:35], s60 offen offset:1024 sc1
    s_mov_b64 exec, -1
    s_endpgm
.section .rodata,"a"
.p2align 6
.amdhsa_kernel standalone__qk_norm__prompt_kernel
  .amdhsa_next_free_vgpr 254
  .amdhsa_next_free_sgpr 72
  .amdhsa_accum_offset 256
  .amdhsa_group_segment_fixed_size 0
  .amdhsa_kernarg_size 56
  .amdhsa_user_sgpr_count 2
  .amdhsa_user_sgpr_kernarg_segment_ptr 1
  .amdhsa_system_sgpr_workgroup_id_x 1
.end_amdhsa_kernel
```
